```python
import torch

def _softmax(x, axis=-1):
    return torch.softmax(x, dim=axis)
def _gelu(x):
    return torch.nn.functional.gelu(x, approximate="tanh")
def _silu(x):
    return torch.nn.functional.silu(x)
def _sigmoid(x):
    return torch.sigmoid(x)
def _layernorm(x, axis=-1, eps=1e-5):
    m = x.mean(dim=axis, keepdim=True)
    v = x.var(dim=axis, keepdim=True, unbiased=False)
    return (x - m) / torch.sqrt(v + eps)
def _scatter_add(tgt, idx, src, axis=0):
    return tgt.clone().index_add_(axis, idx, src)
def _segment_sum(src, seg, n):
    out = torch.zeros((n,) + src.shape[1:], dtype=src.dtype)
    return out.index_add_(0, seg, src)
def _pad(x, pw):
    flat = tuple(v for pair in reversed(pw) for v in pair)
    return torch.nn.functional.pad(x, flat)

kernel_name = 'standalone__kv_cache_quant_int4_int2_kv_with_per_channel_or_per_token_scales__decode'

def setup_inputs():

    _w = (lambda a: (lambda t: t.to(torch.bfloat16) if t.is_floating_point() else t)(torch.as_tensor(a)))
    B = 2
    Sq = 1
    Skv = 32768
    Hq = 32
    Hkv = 16
    Dh = 128
    bits = 2
    G = -1
    if G <= 0 or G >= Skv:
        G = max(1, Skv // 2)
    Skv = (Skv // G) * G
    ngk = Skv // G
    qmax = (1 << bits) - 1
    return {
        "q": _w((lambda *s: torch.randn(*s, dtype=torch.bfloat16) * 3.2)(B, Hq, Sq, Dh)),
        "qk": _w(torch.randint(0, qmax + 1, (B, Hkv, Skv, Dh)).to(torch.int32)),
        "qv": _w(torch.randint(0, qmax + 1, (B, Hkv, Skv, Dh)).to(torch.int32)),
        "k_scales": _w(torch.abs((lambda *s: torch.randn(*s, dtype=torch.bfloat16) * 3.2)(B, Hkv, ngk, Dh)) * 0.05 + 0.02),
        "k_zeros": _w((lambda *s: torch.randn(*s, dtype=torch.bfloat16) * 3.2)(B, Hkv, ngk, Dh) + float(qmax) / 2.0),
        "v_scales": _w(torch.abs((lambda *s: torch.randn(*s, dtype=torch.bfloat16) * 0.05)(B, Hkv, Skv, 1)) * 0.05 + 0.02),
        "v_zeros": _w((lambda *s: torch.randn(*s, dtype=torch.bfloat16) * 0.05)(B, Hkv, Skv, 1) + float(qmax) / 2.0),
    }

def reference(q, qk, qv, k_scales, k_zeros, v_scales, v_zeros):
    B, Hq, Sq, Dh = q.shape
    Hkv, Skv = qk.shape[1], qk.shape[2]
    ngk = k_scales.shape[2]
    G = Skv // ngk
    ks = (lambda x, n, axis: torch.repeat_interleave(x, n, dim=axis))(k_scales, G, axis=2)
    kz = (lambda x, n, axis: torch.repeat_interleave(x, n, dim=axis))(k_zeros, G, axis=2)
    k = ((lambda x, dt: x.to(dt))(qk, q.dtype) - kz) * ks
    v = ((lambda x, dt: x.to(dt))(qv, q.dtype) - v_zeros) * v_scales
    rep = Hq // Hkv
    if rep > 1:
        k = (lambda x, n, axis: torch.repeat_interleave(x, n, dim=axis))(k, rep, axis=1)
        v = (lambda x, n, axis: torch.repeat_interleave(x, n, dim=axis))(v, rep, axis=1)
    scale = float(Dh) ** -0.5
    logits = torch.einsum("bhqd,bhkd->bhqk", q, k) * scale
    p = _softmax(logits, axis=-1)
    o = torch.einsum("bhqk,bhkd->bhqd", p, v)
    return o
```

```asm
; @launch grid=(256,1,1) block=(448,1,1) lds=131968
.amdgcn_target "amdgcn-amd-amdhsa--gfx950"
.text
.globl standalone__kv_cache_quant_int4_int2_kv_with_per_channel_or_per_token_scales__decode_kernel
.p2align 12
.p2align 8
.type standalone__kv_cache_quant_int4_int2_kv_with_per_channel_or_per_token_scales__decode_kernel,@function
standalone__kv_cache_quant_int4_int2_kv_with_per_channel_or_per_token_scales__decode_kernel:
  s_cmp_ge_u32 s2, 256
  s_cbranch_scc1 L_end2
  s_load_dwordx16 s[4:19], s[0:1], 0
  s_load_dwordx4 s[20:23], s[0:1], 64
  s_getreg_b32 s53, hwreg(HW_REG_XCC_ID, 0, 4)
  v_lshrrev_b32 v97, 6, v0
  v_and_b32 v96, 63, v0
  v_readfirstlane_b32 s3, v97
  s_bitcmp1_b32 s53, 2
  s_cselect_b32 s75, 17409, 1
  s_bitcmp1_b32 s2, 0
  s_cselect_b32 s54, 134218752, 0
  s_xor_b32 s75, s75, s54
  s_bitcmp1_b32 s2, 1
  s_cselect_b32 s54, 33556480, 0
  s_xor_b32 s75, s75, s54
  s_bitcmp1_b32 s2, 2
  s_cselect_b32 s54, 268443648, 0
  s_xor_b32 s75, s75, s54
  s_bitcmp1_b32 s2, 3
  s_cselect_b32 s54, 16786432, 0
  s_xor_b32 s75, s75, s54
  s_bitcmp1_b32 s2, 4
  s_cselect_b32 s54, 67128320, 0
  s_xor_b32 s75, s75, s54
  s_bitcmp1_b32 s2, 5
  s_cselect_b32 s54, 8392704, 0
  s_xor_b32 s75, s75, s54
  s_bitcmp1_b32 s2, 6
  s_cselect_b32 s54, 2112512, 0
  s_xor_b32 s75, s75, s54
  s_bitcmp1_b32 s2, 7
  s_cselect_b32 s54, 1054720, 0
  s_xor_b32 s75, s75, s54
  v_mov_b32 v4, 131072
  s_cmp_lg_u32 s3, 4
  s_cbranch_scc1 L_rest
  s_setprio 3
  v_lshlrev_b32 v1, 4, v96
  v_lshl_add_u32 v97, v96, 2, v4
  v_mov_b32 v2, 0
  v_mov_b32 v18, 0
  ds_write_b32 v97, v2
  v_add_u32 v21, 4, v4
  s_mov_b32 s59, 0
  s_mov_b32 s52, 0
  s_mov_b32 s74, -1
  s_movk_i32 s76, 1024
  s_mov_b32 s58, s75
  s_brev_b32 s26, 4
  s_mov_b32 s27, 0x00020000
  s_waitcnt lgkmcnt(0)
  s_mov_b32 s24, s6
  s_and_b32 s25, s7, 0xffff
L_mid:
  s_xor_b32 s73, s58, 1
  s_mov_b32 m0, s59
  s_waitcnt vmcnt(20)
  buffer_load_dwordx4 v1, s[24:27], s73 offen nt lds
  s_xor_b32 s73, s58, 8193
  s_add_u32 m0, m0, s76
  s_waitcnt vmcnt(20)
  buffer_load_dwordx4 v1, s[24:27], s73 offen nt lds
  s_xor_b32 s73, s58, 65537
  s_add_u32 m0, m0, s76
  s_waitcnt vmcnt(20)
  buffer_load_dwordx4 v1, s[24:27], s73 offen nt lds
  s_xor_b32 s73, s58, 73729
  s_add_u32 m0, m0, s76
  s_waitcnt vmcnt(20)
  buffer_load_dwordx4 v1, s[24:27], s73 offen nt lds
  s_cmp_lg_u32 s52, 0
  s_cbranch_scc1 L_nb
  s_barrier
L_nb:
  s_xor_b32 s73, s58, 32769
  s_add_u32 m0, m0, s76
  s_waitcnt vmcnt(20)
  buffer_load_dwordx4 v1, s[24:27], s73 offen nt lds
  v_add_u32 v7, 6, v18
  v_max_u32 v2, v2, v7
  ds_write_b32 v4, v2 offset:0
  s_xor_b32 s73, s58, 40961
  s_add_u32 m0, m0, s76
  s_waitcnt vmcnt(20)
  buffer_load_dwordx4 v1, s[24:27], s73 offen nt lds
  s_xor_b32 s73, s58, 98305
  s_add_u32 m0, m0, s76
  s_waitcnt vmcnt(20)
  buffer_load_dwordx4 v1, s[24:27], s73 offen nt lds
  s_xor_b32 s73, s58, 106497
  s_add_u32 m0, m0, s76
  s_waitcnt vmcnt(20)
  buffer_load_dwordx4 v1, s[24:27], s73 offen nt lds
  s_xor_b32 s73, s58, 4097
  s_add_u32 m0, m0, s76
  s_waitcnt vmcnt(20)
  buffer_load_dwordx4 v1, s[24:27], s73 offen nt lds
  s_xor_b32 s73, s58, 12289
  s_add_u32 m0, m0, s76
  s_waitcnt vmcnt(20)
  buffer_load_dwordx4 v1, s[24:27], s73 offen nt lds
  s_xor_b32 s73, s58, 69633
  s_add_u32 m0, m0, s76
  s_waitcnt vmcnt(20)
  buffer_load_dwordx4 v1, s[24:27], s73 offen nt lds
  s_xor_b32 s73, s58, 77825
  s_add_u32 m0, m0, s76
  s_waitcnt vmcnt(20)
  buffer_load_dwordx4 v1, s[24:27], s73 offen nt lds
  s_xor_b32 s73, s58, 36865
  s_add_u32 m0, m0, s76
  s_waitcnt vmcnt(20)
  buffer_load_dwordx4 v1, s[24:27], s73 offen nt lds
  v_add_u32 v7, 7, v18
  v_max_u32 v2, v2, v7
  ds_write_b32 v4, v2 offset:0
  s_xor_b32 s73, s58, 45057
  s_add_u32 m0, m0, s76
  s_waitcnt vmcnt(20)
  buffer_load_dwordx4 v1, s[24:27], s73 offen nt lds
  s_xor_b32 s73, s58, 102401
  s_add_u32 m0, m0, s76
  s_waitcnt vmcnt(20)
  buffer_load_dwordx4 v1, s[24:27], s73 offen nt lds
  s_xor_b32 s73, s58, 110593
  s_add_u32 m0, m0, s76
  s_waitcnt vmcnt(20)
  buffer_load_dwordx4 v1, s[24:27], s73 offen nt lds
  s_xor_b32 s73, s58, 2049
  s_add_u32 m0, m0, s76
  s_waitcnt vmcnt(20)
  buffer_load_dwordx4 v1, s[24:27], s73 offen nt lds
  s_xor_b32 s73, s58, 10241
  s_add_u32 m0, m0, s76
  s_waitcnt vmcnt(20)
  buffer_load_dwordx4 v1, s[24:27], s73 offen nt lds
  s_xor_b32 s73, s58, 67585
  s_add_u32 m0, m0, s76
  s_waitcnt vmcnt(20)
  buffer_load_dwordx4 v1, s[24:27], s73 offen nt lds
  s_xor_b32 s73, s58, 75777
  s_add_u32 m0, m0, s76
  s_waitcnt vmcnt(20)
  buffer_load_dwordx4 v1, s[24:27], s73 offen nt lds
  s_xor_b32 s73, s58, 34817
  s_add_u32 m0, m0, s76
  s_waitcnt vmcnt(20)
  buffer_load_dwordx4 v1, s[24:27], s73 offen nt lds
  v_add_u32 v7, 8, v18
  v_max_u32 v2, v2, v7
  ds_write_b32 v4, v2 offset:0
  s_xor_b32 s73, s58, 43009
  s_add_u32 m0, m0, s76
  s_waitcnt vmcnt(20)
  buffer_load_dwordx4 v1, s[24:27], s73 offen nt lds
  s_xor_b32 s73, s58, 100353
  s_add_u32 m0, m0, s76
  s_waitcnt vmcnt(20)
  buffer_load_dwordx4 v1, s[24:27], s73 offen nt lds
  s_xor_b32 s73, s58, 108545
  s_add_u32 m0, m0, s76
  s_waitcnt vmcnt(20)
  buffer_load_dwordx4 v1, s[24:27], s73 offen nt lds
  s_memrealtime s[70:71]
  ds_read_b64 v[16:17], v4 offset:32
  ds_read_b32 v20, v21 offset:56
  s_xor_b32 s73, s58, 6145
  s_add_u32 m0, m0, s76
  s_waitcnt vmcnt(20)
  buffer_load_dwordx4 v1, s[24:27], s73 offen nt lds
  s_xor_b32 s73, s58, 14337
  s_add_u32 m0, m0, s76
  s_waitcnt vmcnt(20)
  buffer_load_dwordx4 v1, s[24:27], s73 offen nt lds
  s_xor_b32 s73, s58, 71681
  s_add_u32 m0, m0, s76
  s_waitcnt vmcnt(20)
  buffer_load_dwordx4 v1, s[24:27], s73 offen nt lds
  s_xor_b32 s73, s58, 79873
  s_add_u32 m0, m0, s76
  s_waitcnt vmcnt(20)
  buffer_load_dwordx4 v1, s[24:27], s73 offen nt lds
  s_xor_b32 s73, s58, 38913
  s_add_u32 m0, m0, s76
  s_waitcnt vmcnt(20)
  buffer_load_dwordx4 v1, s[24:27], s73 offen nt lds
  v_add_u32 v7, 9, v18
  v_max_u32 v2, v2, v7
  ds_write_b32 v4, v2 offset:0
  s_waitcnt lgkmcnt(0)
  ds_read_b128 v[12:15], v4 offset:16
  v_mov_b32 v19, s70
  ds_write_b64 v4, v[18:19] offset:40
  s_xor_b32 s73, s58, 47105
  s_add_u32 m0, m0, s76
  s_waitcnt vmcnt(20)
  buffer_load_dwordx4 v1, s[24:27], s73 offen nt lds
  v_readfirstlane_b32 s54, v16
  v_readfirstlane_b32 s55, v17
  s_sub_u32 s72, s70, s54
  s_mul_i32 s55, s55, s52
  s_lshr_b32 s55, s55, 4
  s_cselect_b32 s72, s72, 0
  s_sub_u32 s72, s72, s55
  s_xor_b32 s73, s58, 104449
  s_add_u32 m0, m0, s76
  s_waitcnt vmcnt(20)
  buffer_load_dwordx4 v1, s[24:27], s73 offen nt lds
  s_xor_b32 s73, s58, 112641
  s_add_u32 m0, m0, s76
  s_waitcnt vmcnt(20)
  buffer_load_dwordx4 v1, s[24:27], s73 offen nt lds
L_tail:
  v_readfirstlane_b32 s58, v20
  s_nop 0
  s_bitcmp0_b32 s58, 0
  s_cbranch_scc1 L_retry
  v_add_u32 v21, 8, v18
  v_add_u32 v18, 4, v18
  v_and_b32 v21, 0xff, v21
  v_add_u32 v21, v21, v4
  s_add_u32 s59, s59, 32768
  s_cmp_eq_u32 s59, 98304
  s_cselect_b32 s59, 0, s59
  s_add_u32 s52, s52, 1
  s_and_b32 s54, s52, 63
  s_cbranch_scc0 L_half
L_top:
  s_waitcnt lgkmcnt(0)
L_fc:
  v_min3_i32 v12, v12, v13, v14
  v_min_i32 v12, v12, v15
  s_nop 0
  v_readfirstlane_b32 s54, v12
  s_nop 0
  s_cmp_ge_i32 s54, s74
  s_cbranch_scc1 L_fo
  ds_read_b128 v[12:15], v4 offset:16
  s_waitcnt lgkmcnt(0)
  s_branch L_fc
L_fo:
  s_add_u32 s74, s74, 1
  s_cmp_eq_u32 s52, 127
  s_cbranch_scc1 L_fin
  s_cmp_gt_i32 s72, 15
  s_cbranch_scc1 L_up0
  s_cmp_ge_i32 s72, 0
  s_cbranch_scc1 L_mid
L_dn0:
  s_cmp_lt_i32 s72, -15
  s_cbranch_scc1 L_dn1
L_dn0b:
  s_xor_b32 s73, s58, 1
  s_mov_b32 m0, s59
  s_waitcnt vmcnt(19)
  buffer_load_dwordx4 v1, s[24:27], s73 offen nt lds
  s_xor_b32 s73, s58, 8193
  s_add_u32 m0, m0, s76
  s_waitcnt vmcnt(19)
  buffer_load_dwordx4 v1, s[24:27], s73 offen nt lds
  s_xor_b32 s73, s58, 65537
  s_add_u32 m0, m0, s76
  s_waitcnt vmcnt(19)
  buffer_load_dwordx4 v1, s[24:27], s73 offen nt lds
  s_xor_b32 s73, s58, 73729
  s_add_u32 m0, m0, s76
  s_waitcnt vmcnt(19)
  buffer_load_dwordx4 v1, s[24:27], s73 offen nt lds
  v_add_u32 v7, 6, v18
  v_max_u32 v2, v2, v7
  ds_write_b32 v4, v2 offset:0
  s_xor_b32 s73, s58, 32769
  s_add_u32 m0, m0, s76
  s_waitcnt vmcnt(19)
  buffer_load_dwordx4 v1, s[24:27], s73 offen nt lds
  s_xor_b32 s73, s58, 40961
  s_add_u32 m0, m0, s76
  s_waitcnt vmcnt(19)
  buffer_load_dwordx4 v1, s[24:27], s73 offen nt lds
  s_xor_b32 s73, s58, 98305
  s_add_u32 m0, m0, s76
  s_waitcnt vmcnt(19)
  buffer_load_dwordx4 v1, s[24:27], s73 offen nt lds
  s_xor_b32 s73, s58, 106497
  s_add_u32 m0, m0, s76
  s_waitcnt vmcnt(19)
  buffer_load_dwordx4 v1, s[24:27], s73 offen nt lds
  s_xor_b32 s73, s58, 4097
  s_add_u32 m0, m0, s76
  s_waitcnt vmcnt(19)
  buffer_load_dwordx4 v1, s[24:27], s73 offen nt lds
  s_xor_b32 s73, s58, 12289
  s_add_u32 m0, m0, s76
  s_waitcnt vmcnt(19)
  buffer_load_dwordx4 v1, s[24:27], s73 offen nt lds
  s_xor_b32 s73, s58, 69633
  s_add_u32 m0, m0, s76
  s_waitcnt vmcnt(19)
  buffer_load_dwordx4 v1, s[24:27], s73 offen nt lds
  s_xor_b32 s73, s58, 77825
  s_add_u32 m0, m0, s76
  s_waitcnt vmcnt(19)
  buffer_load_dwordx4 v1, s[24:27], s73 offen nt lds
  v_add_u32 v7, 7, v18
  v_max_u32 v2, v2, v7
  ds_write_b32 v4, v2 offset:0
  s_xor_b32 s73, s58, 36865
  s_add_u32 m0, m0, s76
  s_waitcnt vmcnt(19)
  buffer_load_dwordx4 v1, s[24:27], s73 offen nt lds
  s_xor_b32 s73, s58, 45057
  s_add_u32 m0, m0, s76
  s_waitcnt vmcnt(19)
  buffer_load_dwordx4 v1, s[24:27], s73 offen nt lds
  s_xor_b32 s73, s58, 102401
  s_add_u32 m0, m0, s76
  s_waitcnt vmcnt(19)
  buffer_load_dwordx4 v1, s[24:27], s73 offen nt lds
  s_xor_b32 s73, s58, 110593
  s_add_u32 m0, m0, s76
  s_waitcnt vmcnt(19)
  buffer_load_dwordx4 v1, s[24:27], s73 offen nt lds
  s_xor_b32 s73, s58, 2049
  s_add_u32 m0, m0, s76
  s_waitcnt vmcnt(19)
  buffer_load_dwordx4 v1, s[24:27], s73 offen nt lds
  s_xor_b32 s73, s58, 10241
  s_add_u32 m0, m0, s76
  s_waitcnt vmcnt(19)
  buffer_load_dwordx4 v1, s[24:27], s73 offen nt lds
  s_xor_b32 s73, s58, 67585
  s_add_u32 m0, m0, s76
  s_waitcnt vmcnt(19)
  buffer_load_dwordx4 v1, s[24:27], s73 offen nt lds
  s_xor_b32 s73, s58, 75777
  s_add_u32 m0, m0, s76
  s_waitcnt vmcnt(19)
  buffer_load_dwordx4 v1, s[24:27], s73 offen nt lds
  v_add_u32 v7, 8, v18
  v_max_u32 v2, v2, v7
  ds_write_b32 v4, v2 offset:0
  s_xor_b32 s73, s58, 34817
  s_add_u32 m0, m0, s76
  s_waitcnt vmcnt(19)
  buffer_load_dwordx4 v1, s[24:27], s73 offen nt lds
  s_xor_b32 s73, s58, 43009
  s_add_u32 m0, m0, s76
  s_waitcnt vmcnt(19)
  buffer_load_dwordx4 v1, s[24:27], s73 offen nt lds
  s_xor_b32 s73, s58, 100353
  s_add_u32 m0, m0, s76
  s_waitcnt vmcnt(19)
  buffer_load_dwordx4 v1, s[24:27], s73 offen nt lds
  s_memrealtime s[70:71]
  ds_read_b64 v[16:17], v4 offset:32
  ds_read_b32 v20, v21 offset:56
  s_xor_b32 s73, s58, 108545
  s_add_u32 m0, m0, s76
  s_waitcnt vmcnt(19)
  buffer_load_dwordx4 v1, s[24:27], s73 offen nt lds
  s_xor_b32 s73, s58, 6145
  s_add_u32 m0, m0, s76
  s_waitcnt vmcnt(19)
  buffer_load_dwordx4 v1, s[24:27], s73 offen nt lds
  s_xor_b32 s73, s58, 14337
  s_add_u32 m0, m0, s76
  s_waitcnt vmcnt(19)
  buffer_load_dwordx4 v1, s[24:27], s73 offen nt lds
  s_xor_b32 s73, s58, 71681
  s_add_u32 m0, m0, s76
  s_waitcnt vmcnt(19)
  buffer_load_dwordx4 v1, s[24:27], s73 offen nt lds
  s_xor_b32 s73, s58, 79873
  s_add_u32 m0, m0, s76
  s_waitcnt vmcnt(19)
  buffer_load_dwordx4 v1, s[24:27], s73 offen nt lds
  v_add_u32 v7, 9, v18
  v_max_u32 v2, v2, v7
  ds_write_b32 v4, v2 offset:0
  s_xor_b32 s73, s58, 38913
  s_add_u32 m0, m0, s76
  s_waitcnt vmcnt(19)
  buffer_load_dwordx4 v1, s[24:27], s73 offen nt lds
  s_waitcnt lgkmcnt(0)
  ds_read_b128 v[12:15], v4 offset:16
  v_mov_b32 v19, s70
  ds_write_b64 v4, v[18:19] offset:40
  s_xor_b32 s73, s58, 47105
  s_add_u32 m0, m0, s76
  s_waitcnt vmcnt(19)
  buffer_load_dwordx4 v1, s[24:27], s73 offen nt lds
  v_readfirstlane_b32 s54, v16
  v_readfirstlane_b32 s55, v17
  s_sub_u32 s72, s70, s54
  s_mul_i32 s55, s55, s52
  s_lshr_b32 s55, s55, 4
  s_cselect_b32 s72, s72, 0
  s_sub_u32 s72, s72, s55
  s_xor_b32 s73, s58, 104449
  s_add_u32 m0, m0, s76
  s_waitcnt vmcnt(19)
  buffer_load_dwordx4 v1, s[24:27], s73 offen nt lds
  s_xor_b32 s73, s58, 112641
  s_add_u32 m0, m0, s76
  s_waitcnt vmcnt(19)
  buffer_load_dwordx4 v1, s[24:27], s73 offen nt lds
  s_cbranch_execz L_up0b
  s_branch L_tail
L_up0:
  s_cmp_gt_i32 s72, 40
  s_cbranch_scc1 L_up1
L_up0b:
  s_xor_b32 s73, s58, 1
  s_mov_b32 m0, s59
  s_waitcnt vmcnt(21)
  buffer_load_dwordx4 v1, s[24:27], s73 offen nt lds
  s_xor_b32 s73, s58, 8193
  s_add_u32 m0, m0, s76
  s_waitcnt vmcnt(21)
  buffer_load_dwordx4 v1, s[24:27], s73 offen nt lds
  s_xor_b32 s73, s58, 65537
  s_add_u32 m0, m0, s76
  s_waitcnt vmcnt(21)
  buffer_load_dwordx4 v1, s[24:27], s73 offen nt lds
  s_xor_b32 s73, s58, 73729
  s_add_u32 m0, m0, s76
  s_waitcnt vmcnt(21)
  buffer_load_dwordx4 v1, s[24:27], s73 offen nt lds
  s_xor_b32 s73, s58, 32769
  s_add_u32 m0, m0, s76
  s_waitcnt vmcnt(21)
  buffer_load_dwordx4 v1, s[24:27], s73 offen nt lds
  s_xor_b32 s73, s58, 40961
  s_add_u32 m0, m0, s76
  s_waitcnt vmcnt(21)
  buffer_load_dwordx4 v1, s[24:27], s73 offen nt lds
  v_add_u32 v7, 6, v18
  v_max_u32 v2, v2, v7
  ds_write_b32 v4, v2 offset:0
  s_xor_b32 s73, s58, 98305
  s_add_u32 m0, m0, s76
  s_waitcnt vmcnt(21)
  buffer_load_dwordx4 v1, s[24:27], s73 offen nt lds
  s_xor_b32 s73, s58, 106497
  s_add_u32 m0, m0, s76
  s_waitcnt vmcnt(21)
  buffer_load_dwordx4 v1, s[24:27], s73 offen nt lds
  s_xor_b32 s73, s58, 4097
  s_add_u32 m0, m0, s76
  s_waitcnt vmcnt(21)
  buffer_load_dwordx4 v1, s[24:27], s73 offen nt lds
  s_xor_b32 s73, s58, 12289
  s_add_u32 m0, m0, s76
  s_waitcnt vmcnt(21)
  buffer_load_dwordx4 v1, s[24:27], s73 offen nt lds
  s_xor_b32 s73, s58, 69633
  s_add_u32 m0, m0, s76
  s_waitcnt vmcnt(21)
  buffer_load_dwordx4 v1, s[24:27], s73 offen nt lds
  s_xor_b32 s73, s58, 77825
  s_add_u32 m0, m0, s76
  s_waitcnt vmcnt(21)
  buffer_load_dwordx4 v1, s[24:27], s73 offen nt lds
  s_xor_b32 s73, s58, 36865
  s_add_u32 m0, m0, s76
  s_waitcnt vmcnt(21)
  buffer_load_dwordx4 v1, s[24:27], s73 offen nt lds
  s_xor_b32 s73, s58, 45057
  s_add_u32 m0, m0, s76
  s_waitcnt vmcnt(21)
  buffer_load_dwordx4 v1, s[24:27], s73 offen nt lds
  v_add_u32 v7, 7, v18
  v_max_u32 v2, v2, v7
  ds_write_b32 v4, v2 offset:0
  s_xor_b32 s73, s58, 102401
  s_add_u32 m0, m0, s76
  s_waitcnt vmcnt(21)
  buffer_load_dwordx4 v1, s[24:27], s73 offen nt lds
  s_xor_b32 s73, s58, 110593
  s_add_u32 m0, m0, s76
  s_waitcnt vmcnt(21)
  buffer_load_dwordx4 v1, s[24:27], s73 offen nt lds
  s_xor_b32 s73, s58, 2049
  s_add_u32 m0, m0, s76
  s_waitcnt vmcnt(21)
  buffer_load_dwordx4 v1, s[24:27], s73 offen nt lds
  s_xor_b32 s73, s58, 10241
  s_add_u32 m0, m0, s76
  s_waitcnt vmcnt(21)
  buffer_load_dwordx4 v1, s[24:27], s73 offen nt lds
  s_xor_b32 s73, s58, 67585
  s_add_u32 m0, m0, s76
  s_waitcnt vmcnt(21)
  buffer_load_dwordx4 v1, s[24:27], s73 offen nt lds
  s_xor_b32 s73, s58, 75777
  s_add_u32 m0, m0, s76
  s_waitcnt vmcnt(21)
  buffer_load_dwordx4 v1, s[24:27], s73 offen nt lds
  s_xor_b32 s73, s58, 34817
  s_add_u32 m0, m0, s76
  s_waitcnt vmcnt(21)
  buffer_load_dwordx4 v1, s[24:27], s73 offen nt lds
  s_xor_b32 s73, s58, 43009
  s_add_u32 m0, m0, s76
  s_waitcnt vmcnt(21)
  buffer_load_dwordx4 v1, s[24:27], s73 offen nt lds
  v_add_u32 v7, 8, v18
  v_max_u32 v2, v2, v7
  ds_write_b32 v4, v2 offset:0
  s_xor_b32 s73, s58, 100353
  s_add_u32 m0, m0, s76
  s_waitcnt vmcnt(21)
  buffer_load_dwordx4 v1, s[24:27], s73 offen nt lds
  s_xor_b32 s73, s58, 108545
  s_add_u32 m0, m0, s76
  s_waitcnt vmcnt(21)
  buffer_load_dwordx4 v1, s[24:27], s73 offen nt lds
  s_xor_b32 s73, s58, 6145
  s_add_u32 m0, m0, s76
  s_waitcnt vmcnt(21)
  buffer_load_dwordx4 v1, s[24:27], s73 offen nt lds
  s_memrealtime s[70:71]
  ds_read_b64 v[16:17], v4 offset:32
  ds_read_b32 v20, v21 offset:56
  s_xor_b32 s73, s58, 14337
  s_add_u32 m0, m0, s76
  s_waitcnt vmcnt(21)
  buffer_load_dwordx4 v1, s[24:27], s73 offen nt lds
  s_xor_b32 s73, s58, 71681
  s_add_u32 m0, m0, s76
  s_waitcnt vmcnt(21)
  buffer_load_dwordx4 v1, s[24:27], s73 offen nt lds
  s_xor_b32 s73, s58, 79873
  s_add_u32 m0, m0, s76
  s_waitcnt vmcnt(21)
  buffer_load_dwordx4 v1, s[24:27], s73 offen nt lds
  s_xor_b32 s73, s58, 38913
  s_add_u32 m0, m0, s76
  s_waitcnt vmcnt(21)
  buffer_load_dwordx4 v1, s[24:27], s73 offen nt lds
  s_waitcnt lgkmcnt(0)
  ds_read_b128 v[12:15], v4 offset:16
  v_mov_b32 v19, s70
  ds_write_b64 v4, v[18:19] offset:40
  s_xor_b32 s73, s58, 47105
  s_add_u32 m0, m0, s76
  s_waitcnt vmcnt(21)
  buffer_load_dwordx4 v1, s[24:27], s73 offen nt lds
  v_add_u32 v7, 9, v18
  v_max_u32 v2, v2, v7
  ds_write_b32 v4, v2 offset:0
  v_readfirstlane_b32 s54, v16
  v_readfirstlane_b32 s55, v17
  s_sub_u32 s72, s70, s54
  s_mul_i32 s55, s55, s52
  s_lshr_b32 s55, s55, 4
  s_cselect_b32 s72, s72, 0
  s_sub_u32 s72, s72, s55
  s_xor_b32 s73, s58, 104449
  s_add_u32 m0, m0, s76
  s_waitcnt vmcnt(21)
  buffer_load_dwordx4 v1, s[24:27], s73 offen nt lds
  s_xor_b32 s73, s58, 112641
  s_add_u32 m0, m0, s76
  s_waitcnt vmcnt(21)
  buffer_load_dwordx4 v1, s[24:27], s73 offen nt lds
  s_cbranch_execz L_dn1b
  s_branch L_tail
L_rest:
  s_mov_b32 s49, s2
  s_lshr_b32 s48, s75, 24
  s_bfe_u32 s54, s2, 196613
  s_lshl3_add_u32 s2, s48, s54
  s_cmp_eq_u32 s3, 6
  s_cbranch_scc1 L_zs
  s_barrier
  s_cmp_lt_u32 s3, 4
  s_cbranch_scc1 L_cons
  s_branch L_helper
L_zs:
  s_barrier
  v_lshl_or_b32 v5, s54, 6, v96
  s_lshr_b32 s55, s75, 8
  v_mov_b32 v1, s55
  v_bfe_i32 v3, v5, 0, 1
  v_and_b32 v3, 16, v3
  v_xor_b32 v1, v1, v3
  v_bfe_i32 v3, v5, 1, 1
  v_and_b32 v3, 32, v3
  v_xor_b32 v1, v1, v3
  v_bfe_i32 v3, v5, 2, 1
  v_and_b32 v3, 64, v3
  v_xor_b32 v1, v1, v3
  v_bfe_i32 v3, v5, 3, 1
  v_and_b32 v3, 128, v3
  v_xor_b32 v1, v1, v3
  v_bfe_i32 v3, v5, 4, 1
  v_and_b32 v3, 256, v3
  v_xor_b32 v1, v1, v3
  v_bfe_i32 v3, v5, 5, 1
  v_and_b32 v3, 512, v3
  v_xor_b32 v1, v1, v3
  v_bfe_i32 v3, v5, 6, 1
  v_and_b32 v3, 1024, v3
  v_xor_b32 v1, v1, v3
  v_bfe_i32 v3, v5, 7, 1
  v_and_b32 v3, 2048, v3
  v_xor_b32 v1, v1, v3
  v_bfe_i32 v3, v5, 8, 1
  v_and_b32 v3, 16384, v3
  v_xor_b32 v1, v1, v3
  v_and_b32 v1, -16, v1
  s_waitcnt lgkmcnt(0)
  s_mov_b32 s28, s16
  s_and_b32 s29, s17, 0xffff
  s_mov_b32 s30, 2097152
  s_mov_b32 s31, 0x00020000
  s_mov_b32 s32, s14
  s_and_b32 s33, s15, 0xffff
  s_mov_b32 s34, 2097152
  s_mov_b32 s35, 0x00020000
  v_xor_b32 v6, 0, v1
  buffer_load_dwordx4 v[8:11], v6, s[28:31], 0 offen nt
  buffer_load_dwordx4 v[12:15], v6, s[32:35], 0 offen nt
  v_xor_b32 v7, 1024, v1
  buffer_load_dwordx4 v[16:19], v7, s[28:31], 0 offen nt
  buffer_load_dwordx4 v[20:23], v7, s[32:35], 0 offen nt
  v_xor_b32 v6, 2048, v1
  buffer_load_dwordx4 v[24:27], v6, s[28:31], 0 offen nt
  buffer_load_dwordx4 v[28:31], v6, s[32:35], 0 offen nt
  v_xor_b32 v7, 3072, v1
  buffer_load_dwordx4 v[32:35], v7, s[28:31], 0 offen nt
  buffer_load_dwordx4 v[36:39], v7, s[32:35], 0 offen nt
  v_xor_b32 v6, 16384, v1
  buffer_load_dwordx4 v[40:43], v6, s[28:31], 0 offen nt
  buffer_load_dwordx4 v[44:47], v6, s[32:35], 0 offen nt
  v_xor_b32 v7, 17408, v1
  buffer_load_dwordx4 v[48:51], v7, s[28:31], 0 offen nt
  buffer_load_dwordx4 v[52:55], v7, s[32:35], 0 offen nt
  v_xor_b32 v6, 18432, v1
  buffer_load_dwordx4 v[56:59], v6, s[28:31], 0 offen nt
  buffer_load_dwordx4 v[60:63], v6, s[32:35], 0 offen nt
  v_xor_b32 v7, 19456, v1
  buffer_load_dwordx4 v[64:67], v7, s[28:31], 0 offen nt
  buffer_load_dwordx4 v[68:71], v7, s[32:35], 0 offen nt
  v_mov_b32 v2, s75
  v_bfe_i32 v3, v96, 0, 1
  v_and_b32 v3, 1024, v3
  v_xor_b32 v2, v2, v3
  v_bfe_i32 v3, v96, 1, 1
  v_and_b32 v3, 541696, v3
  v_xor_b32 v2, v2, v3
  v_bfe_i32 v3, v96, 2, 1
  v_and_b32 v3, 4194304, v3
  v_xor_b32 v2, v2, v3
  v_bfe_i32 v3, v96, 3, 1
  v_and_b32 v3, 132096, v3
  v_xor_b32 v2, v2, v3
  v_bfe_i32 v3, v96, 4, 1
  v_and_b32 v3, 264192, v3
  v_xor_b32 v2, v2, v3
  v_bfe_i32 v3, v96, 5, 1
  v_and_b32 v3, 17408, v3
  v_xor_b32 v2, v2, v3
  v_lshl_add_u32 v3, v96, 2, v4
  ds_write_b32 v3, v2 offset:56
  v_mov_b32 v2, 0
  v_bfe_i32 v3, v5, 0, 1
  v_and_b32 v3, 32, v3
  v_xor_b32 v2, v2, v3
  v_bfe_i32 v3, v5, 1, 1
  v_and_b32 v3, 4, v3
  v_xor_b32 v2, v2, v3
  v_bfe_i32 v3, v5, 2, 1
  v_and_b32 v3, 4224, v3
  v_xor_b32 v2, v2, v3
  v_bfe_i32 v3, v5, 3, 1
  v_and_b32 v3, 16, v3
  v_xor_b32 v2, v2, v3
  v_bfe_i32 v3, v5, 4, 1
  v_and_b32 v3, 8, v3
  v_xor_b32 v2, v2, v3
  v_bfe_i32 v3, v5, 5, 1
  v_and_b32 v3, 1152, v3
  v_xor_b32 v2, v2, v3
  v_bfe_i32 v3, v5, 6, 1
  v_and_b32 v3, 2112, v3
  v_xor_b32 v2, v2, v3
  v_bfe_i32 v3, v5, 7, 1
  v_and_b32 v3, 4352, v3
  v_xor_b32 v2, v2, v3
  v_bfe_i32 v3, v5, 8, 1
  v_and_b32 v3, 512, v3
  v_xor_b32 v2, v2, v3
  s_bitcmp1_b32 s75, 10
  s_cselect_b32 s55, 128, 0
  v_xor_b32 v2, s55, v2
  s_bitcmp1_b32 s75, 11
  s_cselect_b32 s55, 64, 0
  v_xor_b32 v2, s55, v2
  s_waitcnt vmcnt(14)
  v_xor_b32 v6, 114688, v2
  ds_write2st64_b32 v6, v8, v12 offset1:32
  v_xor_b32 v7, 114816, v2
  ds_write2st64_b32 v7, v9, v13 offset1:32
  v_xor_b32 v6, 114752, v2
  ds_write2st64_b32 v6, v10, v14 offset1:32
  v_xor_b32 v7, 114880, v2
  ds_write2st64_b32 v7, v11, v15 offset1:32
  s_waitcnt vmcnt(12)
  v_xor_b32 v7, 116800, v2
  ds_write2st64_b32 v7, v16, v20 offset1:32
  v_xor_b32 v6, 116928, v2
  ds_write2st64_b32 v6, v17, v21 offset1:32
  v_xor_b32 v7, 116736, v2
  ds_write2st64_b32 v7, v18, v22 offset1:32
  v_xor_b32 v6, 116864, v2
  ds_write2st64_b32 v6, v19, v23 offset1:32
  s_waitcnt vmcnt(10)
  v_xor_b32 v6, 119040, v2
  ds_write2st64_b32 v6, v24, v28 offset1:32
  v_xor_b32 v7, 119168, v2
  ds_write2st64_b32 v7, v25, v29 offset1:32
  v_xor_b32 v6, 119104, v2
  ds_write2st64_b32 v6, v26, v30 offset1:32
  v_xor_b32 v7, 119232, v2
  ds_write2st64_b32 v7, v27, v31 offset1:32
  s_waitcnt vmcnt(8)
  v_xor_b32 v7, 121152, v2
  ds_write2st64_b32 v7, v32, v36 offset1:32
  v_xor_b32 v6, 121280, v2
  ds_write2st64_b32 v6, v33, v37 offset1:32
  v_xor_b32 v7, 121088, v2
  ds_write2st64_b32 v7, v34, v38 offset1:32
  v_xor_b32 v6, 121216, v2
  ds_write2st64_b32 v6, v35, v39 offset1:32
  s_waitcnt vmcnt(6)
  v_xor_b32 v6, 115200, v2
  ds_write2st64_b32 v6, v40, v44 offset1:32
  v_xor_b32 v7, 115328, v2
  ds_write2st64_b32 v7, v41, v45 offset1:32
  v_xor_b32 v6, 115264, v2
  ds_write2st64_b32 v6, v42, v46 offset1:32
  v_xor_b32 v7, 115392, v2
  ds_write2st64_b32 v7, v43, v47 offset1:32
  s_waitcnt vmcnt(4)
  v_xor_b32 v7, 117312, v2
  ds_write2st64_b32 v7, v48, v52 offset1:32
  v_xor_b32 v6, 117440, v2
  ds_write2st64_b32 v6, v49, v53 offset1:32
  v_xor_b32 v7, 117248, v2
  ds_write2st64_b32 v7, v50, v54 offset1:32
  v_xor_b32 v6, 117376, v2
  ds_write2st64_b32 v6, v51, v55 offset1:32
  s_waitcnt vmcnt(2)
  v_xor_b32 v6, 119552, v2
  ds_write2st64_b32 v6, v56, v60 offset1:32
  v_xor_b32 v7, 119680, v2
  ds_write2st64_b32 v7, v57, v61 offset1:32
  v_xor_b32 v6, 119616, v2
  ds_write2st64_b32 v6, v58, v62 offset1:32
  v_xor_b32 v7, 119744, v2
  ds_write2st64_b32 v7, v59, v63 offset1:32
  s_waitcnt vmcnt(0)
  v_xor_b32 v7, 121664, v2
  ds_write2st64_b32 v7, v64, v68 offset1:32
  v_xor_b32 v6, 121792, v2
  ds_write2st64_b32 v6, v65, v69 offset1:32
  v_xor_b32 v7, 121600, v2
  ds_write2st64_b32 v7, v66, v70 offset1:32
  v_xor_b32 v6, 121728, v2
  ds_write2st64_b32 v6, v67, v71 offset1:32
  v_mov_b32 v3, 1
  s_mov_b64 exec, 1
  s_waitcnt lgkmcnt(0)
  ds_add_u32 v4, v3 offset:4
  s_waitcnt lgkmcnt(0)
  s_mov_b64 exec, -1
  s_mov_b32 s24, s22
  s_and_b32 s25, s23, 0xffff
  s_mov_b32 s26, 524288
  s_mov_b32 s27, 0x00020000
  s_lshl_b32 s54, s2, 10
  s_lshl_b32 s55, s2, 5
  s_bitset1_b32 s55, 18
  v_lshlrev_b32 v1, 4, v96
  s_mov_b64 exec, -1
  buffer_load_dwordx4 v[8:11], v1, s[24:27], s54 offen nt
  s_mov_b64 exec, 3
  buffer_load_dwordx4 v[12:15], v1, s[24:27], s55 offen nt
  s_waitcnt vmcnt(0)
  s_mov_b64 exec, -1
  buffer_load_dwordx4 v[8:11], v1, s[24:27], s54 offen sc1
  s_mov_b64 exec, 3
  buffer_load_dwordx4 v[12:15], v1, s[24:27], s55 offen sc1
  s_waitcnt vmcnt(0)
  s_mov_b64 exec, -1
  v_mov_b32 v1, 0
  v_mov_b32 v21, v4
  s_mov_b32 s24, s6
  s_and_b32 s25, s7, 0xffff
  s_mov_b32 s26, 536870912
  s_mov_b32 s27, 0x00020000
  s_mov_b32 s58, 1
  s_mov_b32 s59, 0
  s_mov_b32 s52, 1
  s_movk_i32 s76, 1024
  s_mov_b64 exec, 0
  s_branch L_dn0b
  s_endpgm
L_dn1:
  s_cmp_lt_i32 s72, -30
  s_cbranch_scc1 L_dn2
L_dn1b:
  s_xor_b32 s73, s58, 1
  s_mov_b32 m0, s59
  s_waitcnt vmcnt(18)
  buffer_load_dwordx4 v1, s[24:27], s73 offen nt lds
  s_xor_b32 s73, s58, 8193
  s_add_u32 m0, m0, s76
  s_waitcnt vmcnt(18)
  buffer_load_dwordx4 v1, s[24:27], s73 offen nt lds
  s_xor_b32 s73, s58, 65537
  s_add_u32 m0, m0, s76
  s_waitcnt vmcnt(18)
  buffer_load_dwordx4 v1, s[24:27], s73 offen nt lds
  v_add_u32 v7, 6, v18
  v_max_u32 v2, v2, v7
  ds_write_b32 v4, v2 offset:0
  s_xor_b32 s73, s58, 73729
  s_add_u32 m0, m0, s76
  s_waitcnt vmcnt(18)
  buffer_load_dwordx4 v1, s[24:27], s73 offen nt lds
  s_xor_b32 s73, s58, 32769
  s_add_u32 m0, m0, s76
  s_waitcnt vmcnt(18)
  buffer_load_dwordx4 v1, s[24:27], s73 offen nt lds
  s_xor_b32 s73, s58, 40961
  s_add_u32 m0, m0, s76
  s_waitcnt vmcnt(18)
  buffer_load_dwordx4 v1, s[24:27], s73 offen nt lds
  s_xor_b32 s73, s58, 98305
  s_add_u32 m0, m0, s76
  s_waitcnt vmcnt(18)
  buffer_load_dwordx4 v1, s[24:27], s73 offen nt lds
  s_xor_b32 s73, s58, 106497
  s_add_u32 m0, m0, s76
  s_waitcnt vmcnt(18)
  buffer_load_dwordx4 v1, s[24:27], s73 offen nt lds
  s_xor_b32 s73, s58, 4097
  s_add_u32 m0, m0, s76
  s_waitcnt vmcnt(18)
  buffer_load_dwordx4 v1, s[24:27], s73 offen nt lds
  s_xor_b32 s73, s58, 12289
  s_add_u32 m0, m0, s76
  s_waitcnt vmcnt(18)
  buffer_load_dwordx4 v1, s[24:27], s73 offen nt lds
  s_xor_b32 s73, s58, 69633
  s_add_u32 m0, m0, s76
  s_waitcnt vmcnt(18)
  buffer_load_dwordx4 v1, s[24:27], s73 offen nt lds
  v_add_u32 v7, 7, v18
  v_max_u32 v2, v2, v7
  ds_write_b32 v4, v2 offset:0
  s_xor_b32 s73, s58, 77825
  s_add_u32 m0, m0, s76
  s_waitcnt vmcnt(18)
  buffer_load_dwordx4 v1, s[24:27], s73 offen nt lds
  s_xor_b32 s73, s58, 36865
  s_add_u32 m0, m0, s76
  s_waitcnt vmcnt(18)
  buffer_load_dwordx4 v1, s[24:27], s73 offen nt lds
  s_xor_b32 s73, s58, 45057
  s_add_u32 m0, m0, s76
  s_waitcnt vmcnt(18)
  buffer_load_dwordx4 v1, s[24:27], s73 offen nt lds
  s_xor_b32 s73, s58, 102401
  s_add_u32 m0, m0, s76
  s_waitcnt vmcnt(18)
  buffer_load_dwordx4 v1, s[24:27], s73 offen nt lds
  s_xor_b32 s73, s58, 110593
  s_add_u32 m0, m0, s76
  s_waitcnt vmcnt(18)
  buffer_load_dwordx4 v1, s[24:27], s73 offen nt lds
  s_xor_b32 s73, s58, 2049
  s_add_u32 m0, m0, s76
  s_waitcnt vmcnt(18)
  buffer_load_dwordx4 v1, s[24:27], s73 offen nt lds
  s_xor_b32 s73, s58, 10241
  s_add_u32 m0, m0, s76
  s_waitcnt vmcnt(18)
  buffer_load_dwordx4 v1, s[24:27], s73 offen nt lds
  s_xor_b32 s73, s58, 67585
  s_add_u32 m0, m0, s76
  s_waitcnt vmcnt(18)
  buffer_load_dwordx4 v1, s[24:27], s73 offen nt lds
  v_add_u32 v7, 8, v18
  v_max_u32 v2, v2, v7
  ds_write_b32 v4, v2 offset:0
  s_xor_b32 s73, s58, 75777
  s_add_u32 m0, m0, s76
  s_waitcnt vmcnt(18)
  buffer_load_dwordx4 v1, s[24:27], s73 offen nt lds
  s_xor_b32 s73, s58, 34817
  s_add_u32 m0, m0, s76
  s_waitcnt vmcnt(18)
  buffer_load_dwordx4 v1, s[24:27], s73 offen nt lds
  s_xor_b32 s73, s58, 43009
  s_add_u32 m0, m0, s76
  s_waitcnt vmcnt(18)
  buffer_load_dwordx4 v1, s[24:27], s73 offen nt lds
  s_memrealtime s[70:71]
  ds_read_b64 v[16:17], v4 offset:32
  ds_read_b32 v20, v21 offset:56
  s_xor_b32 s73, s58, 100353
  s_add_u32 m0, m0, s76
  s_waitcnt vmcnt(18)
  buffer_load_dwordx4 v1, s[24:27], s73 offen nt lds
  s_xor_b32 s73, s58, 108545
  s_add_u32 m0, m0, s76
  s_waitcnt vmcnt(18)
  buffer_load_dwordx4 v1, s[24:27], s73 offen nt lds
  s_xor_b32 s73, s58, 6145
  s_add_u32 m0, m0, s76
  s_waitcnt vmcnt(18)
  buffer_load_dwordx4 v1, s[24:27], s73 offen nt lds
  s_xor_b32 s73, s58, 14337
  s_add_u32 m0, m0, s76
  s_waitcnt vmcnt(18)
  buffer_load_dwordx4 v1, s[24:27], s73 offen nt lds
  s_xor_b32 s73, s58, 71681
  s_add_u32 m0, m0, s76
  s_waitcnt vmcnt(18)
  buffer_load_dwordx4 v1, s[24:27], s73 offen nt lds
  v_add_u32 v7, 9, v18
  v_max_u32 v2, v2, v7
  ds_write_b32 v4, v2 offset:0
  s_xor_b32 s73, s58, 79873
  s_add_u32 m0, m0, s76
  s_waitcnt vmcnt(18)
  buffer_load_dwordx4 v1, s[24:27], s73 offen nt lds
  s_xor_b32 s73, s58, 38913
  s_add_u32 m0, m0, s76
  s_waitcnt vmcnt(18)
  buffer_load_dwordx4 v1, s[24:27], s73 offen nt lds
  s_waitcnt lgkmcnt(0)
  ds_read_b128 v[12:15], v4 offset:16
  v_mov_b32 v19, s70
  ds_write_b64 v4, v[18:19] offset:40
  s_xor_b32 s73, s58, 47105
  s_add_u32 m0, m0, s76
  s_waitcnt vmcnt(18)
  buffer_load_dwordx4 v1, s[24:27], s73 offen nt lds
  v_readfirstlane_b32 s54, v16
  v_readfirstlane_b32 s55, v17
  s_sub_u32 s72, s70, s54
  s_mul_i32 s55, s55, s52
  s_lshr_b32 s55, s55, 4
  s_cselect_b32 s72, s72, 0
  s_sub_u32 s72, s72, s55
  s_xor_b32 s73, s58, 104449
  s_add_u32 m0, m0, s76
  s_waitcnt vmcnt(18)
  buffer_load_dwordx4 v1, s[24:27], s73 offen nt lds
  s_xor_b32 s73, s58, 112641
  s_add_u32 m0, m0, s76
  s_waitcnt vmcnt(18)
  buffer_load_dwordx4 v1, s[24:27], s73 offen nt lds
  s_cbranch_execz L_dn2b
  s_branch L_tail
L_dn2:
L_dn2b:
  s_xor_b32 s73, s58, 1
  s_mov_b32 m0, s59
  s_waitcnt vmcnt(16)
  buffer_load_dwordx4 v1, s[24:27], s73 offen nt lds
  v_add_u32 v7, 6, v18
  v_max_u32 v2, v2, v7
  ds_write_b32 v4, v2 offset:0
  s_xor_b32 s73, s58, 8193
  s_add_u32 m0, m0, s76
  s_waitcnt vmcnt(16)
  buffer_load_dwordx4 v1, s[24:27], s73 offen nt lds
  s_xor_b32 s73, s58, 65537
  s_add_u32 m0, m0, s76
  s_waitcnt vmcnt(16)
  buffer_load_dwordx4 v1, s[24:27], s73 offen nt lds
  s_xor_b32 s73, s58, 73729
  s_add_u32 m0, m0, s76
  s_waitcnt vmcnt(16)
  buffer_load_dwordx4 v1, s[24:27], s73 offen nt lds
  s_xor_b32 s73, s58, 32769
  s_add_u32 m0, m0, s76
  s_waitcnt vmcnt(16)
  buffer_load_dwordx4 v1, s[24:27], s73 offen nt lds
  s_xor_b32 s73, s58, 40961
  s_add_u32 m0, m0, s76
  s_waitcnt vmcnt(16)
  buffer_load_dwordx4 v1, s[24:27], s73 offen nt lds
  s_xor_b32 s73, s58, 98305
  s_add_u32 m0, m0, s76
  s_waitcnt vmcnt(16)
  buffer_load_dwordx4 v1, s[24:27], s73 offen nt lds
  s_xor_b32 s73, s58, 106497
  s_add_u32 m0, m0, s76
  s_waitcnt vmcnt(16)
  buffer_load_dwordx4 v1, s[24:27], s73 offen nt lds
  s_xor_b32 s73, s58, 4097
  s_add_u32 m0, m0, s76
  s_waitcnt vmcnt(16)
  buffer_load_dwordx4 v1, s[24:27], s73 offen nt lds
  v_add_u32 v7, 7, v18
  v_max_u32 v2, v2, v7
  ds_write_b32 v4, v2 offset:0
  s_xor_b32 s73, s58, 12289
  s_add_u32 m0, m0, s76
  s_waitcnt vmcnt(16)
  buffer_load_dwordx4 v1, s[24:27], s73 offen nt lds
  s_xor_b32 s73, s58, 69633
  s_add_u32 m0, m0, s76
  s_waitcnt vmcnt(16)
  buffer_load_dwordx4 v1, s[24:27], s73 offen nt lds
  s_xor_b32 s73, s58, 77825
  s_add_u32 m0, m0, s76
  s_waitcnt vmcnt(16)
  buffer_load_dwordx4 v1, s[24:27], s73 offen nt lds
  s_xor_b32 s73, s58, 36865
  s_add_u32 m0, m0, s76
  s_waitcnt vmcnt(16)
  buffer_load_dwordx4 v1, s[24:27], s73 offen nt lds
  s_xor_b32 s73, s58, 45057
  s_add_u32 m0, m0, s76
  s_waitcnt vmcnt(16)
  buffer_load_dwordx4 v1, s[24:27], s73 offen nt lds
  s_xor_b32 s73, s58, 102401
  s_add_u32 m0, m0, s76
  s_waitcnt vmcnt(16)
  buffer_load_dwordx4 v1, s[24:27], s73 offen nt lds
  s_xor_b32 s73, s58, 110593
  s_add_u32 m0, m0, s76
  s_waitcnt vmcnt(16)
  buffer_load_dwordx4 v1, s[24:27], s73 offen nt lds
  s_xor_b32 s73, s58, 2049
  s_add_u32 m0, m0, s76
  s_waitcnt vmcnt(16)
  buffer_load_dwordx4 v1, s[24:27], s73 offen nt lds
  v_add_u32 v7, 8, v18
  v_max_u32 v2, v2, v7
  ds_write_b32 v4, v2 offset:0
  s_xor_b32 s73, s58, 10241
  s_add_u32 m0, m0, s76
  s_waitcnt vmcnt(16)
  buffer_load_dwordx4 v1, s[24:27], s73 offen nt lds
  s_xor_b32 s73, s58, 67585
  s_add_u32 m0, m0, s76
  s_waitcnt vmcnt(16)
  buffer_load_dwordx4 v1, s[24:27], s73 offen nt lds
  s_xor_b32 s73, s58, 75777
  s_add_u32 m0, m0, s76
  s_waitcnt vmcnt(16)
  buffer_load_dwordx4 v1, s[24:27], s73 offen nt lds
  s_memrealtime s[70:71]
  ds_read_b64 v[16:17], v4 offset:32
  ds_read_b32 v20, v21 offset:56
  s_xor_b32 s73, s58, 34817
  s_add_u32 m0, m0, s76
  s_waitcnt vmcnt(16)
  buffer_load_dwordx4 v1, s[24:27], s73 offen nt lds
  s_xor_b32 s73, s58, 43009
  s_add_u32 m0, m0, s76
  s_waitcnt vmcnt(16)
  buffer_load_dwordx4 v1, s[24:27], s73 offen nt lds
  s_xor_b32 s73, s58, 100353
  s_add_u32 m0, m0, s76
  s_waitcnt vmcnt(16)
  buffer_load_dwordx4 v1, s[24:27], s73 offen nt lds
  s_xor_b32 s73, s58, 108545
  s_add_u32 m0, m0, s76
  s_waitcnt vmcnt(16)
  buffer_load_dwordx4 v1, s[24:27], s73 offen nt lds
  s_xor_b32 s73, s58, 6145
  s_add_u32 m0, m0, s76
  s_waitcnt vmcnt(16)
  buffer_load_dwordx4 v1, s[24:27], s73 offen nt lds
  v_add_u32 v7, 9, v18
  v_max_u32 v2, v2, v7
  ds_write_b32 v4, v2 offset:0
  s_xor_b32 s73, s58, 14337
  s_add_u32 m0, m0, s76
  s_waitcnt vmcnt(16)
  buffer_load_dwordx4 v1, s[24:27], s73 offen nt lds
  s_xor_b32 s73, s58, 71681
  s_add_u32 m0, m0, s76
  s_waitcnt vmcnt(16)
  buffer_load_dwordx4 v1, s[24:27], s73 offen nt lds
  s_xor_b32 s73, s58, 79873
  s_add_u32 m0, m0, s76
  s_waitcnt vmcnt(16)
  buffer_load_dwordx4 v1, s[24:27], s73 offen nt lds
  s_xor_b32 s73, s58, 38913
  s_add_u32 m0, m0, s76
  s_waitcnt vmcnt(16)
  buffer_load_dwordx4 v1, s[24:27], s73 offen nt lds
  s_waitcnt lgkmcnt(0)
  ds_read_b128 v[12:15], v4 offset:16
  v_mov_b32 v19, s70
  ds_write_b64 v4, v[18:19] offset:40
  s_xor_b32 s73, s58, 47105
  s_add_u32 m0, m0, s76
  s_waitcnt vmcnt(16)
  buffer_load_dwordx4 v1, s[24:27], s73 offen nt lds
  v_readfirstlane_b32 s54, v16
  v_readfirstlane_b32 s55, v17
  s_sub_u32 s72, s70, s54
  s_mul_i32 s55, s55, s52
  s_lshr_b32 s55, s55, 4
  s_cselect_b32 s72, s72, 0
  s_sub_u32 s72, s72, s55
  s_xor_b32 s73, s58, 104449
  s_add_u32 m0, m0, s76
  s_waitcnt vmcnt(16)
  buffer_load_dwordx4 v1, s[24:27], s73 offen nt lds
  s_xor_b32 s73, s58, 112641
  s_add_u32 m0, m0, s76
  s_waitcnt vmcnt(16)
  buffer_load_dwordx4 v1, s[24:27], s73 offen nt lds
  s_cbranch_execz L_up1b
  s_branch L_tail
L_up1:
  s_cmp_gt_i32 s72, 100
  s_cbranch_scc1 L_up2
L_up1b:
  s_xor_b32 s73, s58, 1
  s_mov_b32 m0, s59
  s_waitcnt vmcnt(22)
  buffer_load_dwordx4 v1, s[24:27], s73 offen nt lds
  s_xor_b32 s73, s58, 8193
  s_add_u32 m0, m0, s76
  s_waitcnt vmcnt(22)
  buffer_load_dwordx4 v1, s[24:27], s73 offen nt lds
  s_xor_b32 s73, s58, 65537
  s_add_u32 m0, m0, s76
  s_waitcnt vmcnt(22)
  buffer_load_dwordx4 v1, s[24:27], s73 offen nt lds
  s_xor_b32 s73, s58, 73729
  s_add_u32 m0, m0, s76
  s_waitcnt vmcnt(22)
  buffer_load_dwordx4 v1, s[24:27], s73 offen nt lds
  s_xor_b32 s73, s58, 32769
  s_add_u32 m0, m0, s76
  s_waitcnt vmcnt(22)
  buffer_load_dwordx4 v1, s[24:27], s73 offen nt lds
  s_xor_b32 s73, s58, 40961
  s_add_u32 m0, m0, s76
  s_waitcnt vmcnt(22)
  buffer_load_dwordx4 v1, s[24:27], s73 offen nt lds
  s_xor_b32 s73, s58, 98305
  s_add_u32 m0, m0, s76
  s_waitcnt vmcnt(22)
  buffer_load_dwordx4 v1, s[24:27], s73 offen nt lds
  v_add_u32 v7, 6, v18
  v_max_u32 v2, v2, v7
  ds_write_b32 v4, v2 offset:0
  s_xor_b32 s73, s58, 106497
  s_add_u32 m0, m0, s76
  s_waitcnt vmcnt(22)
  buffer_load_dwordx4 v1, s[24:27], s73 offen nt lds
  s_xor_b32 s73, s58, 4097
  s_add_u32 m0, m0, s76
  s_waitcnt vmcnt(22)
  buffer_load_dwordx4 v1, s[24:27], s73 offen nt lds
  s_xor_b32 s73, s58, 12289
  s_add_u32 m0, m0, s76
  s_waitcnt vmcnt(22)
  buffer_load_dwordx4 v1, s[24:27], s73 offen nt lds
  s_xor_b32 s73, s58, 69633
  s_add_u32 m0, m0, s76
  s_waitcnt vmcnt(22)
  buffer_load_dwordx4 v1, s[24:27], s73 offen nt lds
  s_xor_b32 s73, s58, 77825
  s_add_u32 m0, m0, s76
  s_waitcnt vmcnt(22)
  buffer_load_dwordx4 v1, s[24:27], s73 offen nt lds
  s_xor_b32 s73, s58, 36865
  s_add_u32 m0, m0, s76
  s_waitcnt vmcnt(22)
  buffer_load_dwordx4 v1, s[24:27], s73 offen nt lds
  s_xor_b32 s73, s58, 45057
  s_add_u32 m0, m0, s76
  s_waitcnt vmcnt(22)
  buffer_load_dwordx4 v1, s[24:27], s73 offen nt lds
  s_xor_b32 s73, s58, 102401
  s_add_u32 m0, m0, s76
  s_waitcnt vmcnt(22)
  buffer_load_dwordx4 v1, s[24:27], s73 offen nt lds
  v_add_u32 v7, 7, v18
  v_max_u32 v2, v2, v7
  ds_write_b32 v4, v2 offset:0
  s_xor_b32 s73, s58, 110593
  s_add_u32 m0, m0, s76
  s_waitcnt vmcnt(22)
  buffer_load_dwordx4 v1, s[24:27], s73 offen nt lds
  s_xor_b32 s73, s58, 2049
  s_add_u32 m0, m0, s76
  s_waitcnt vmcnt(22)
  buffer_load_dwordx4 v1, s[24:27], s73 offen nt lds
  s_xor_b32 s73, s58, 10241
  s_add_u32 m0, m0, s76
  s_waitcnt vmcnt(22)
  buffer_load_dwordx4 v1, s[24:27], s73 offen nt lds
  s_xor_b32 s73, s58, 67585
  s_add_u32 m0, m0, s76
  s_waitcnt vmcnt(22)
  buffer_load_dwordx4 v1, s[24:27], s73 offen nt lds
  s_xor_b32 s73, s58, 75777
  s_add_u32 m0, m0, s76
  s_waitcnt vmcnt(22)
  buffer_load_dwordx4 v1, s[24:27], s73 offen nt lds
  s_xor_b32 s73, s58, 34817
  s_add_u32 m0, m0, s76
  s_waitcnt vmcnt(22)
  buffer_load_dwordx4 v1, s[24:27], s73 offen nt lds
  s_xor_b32 s73, s58, 43009
  s_add_u32 m0, m0, s76
  s_waitcnt vmcnt(22)
  buffer_load_dwordx4 v1, s[24:27], s73 offen nt lds
  s_xor_b32 s73, s58, 100353
  s_add_u32 m0, m0, s76
  s_waitcnt vmcnt(22)
  buffer_load_dwordx4 v1, s[24:27], s73 offen nt lds
  v_add_u32 v7, 8, v18
  v_max_u32 v2, v2, v7
  ds_write_b32 v4, v2 offset:0
  s_xor_b32 s73, s58, 108545
  s_add_u32 m0, m0, s76
  s_waitcnt vmcnt(22)
  buffer_load_dwordx4 v1, s[24:27], s73 offen nt lds
  s_xor_b32 s73, s58, 6145
  s_add_u32 m0, m0, s76
  s_waitcnt vmcnt(22)
  buffer_load_dwordx4 v1, s[24:27], s73 offen nt lds
  s_xor_b32 s73, s58, 14337
  s_add_u32 m0, m0, s76
  s_waitcnt vmcnt(22)
  buffer_load_dwordx4 v1, s[24:27], s73 offen nt lds
  s_memrealtime s[70:71]
  ds_read_b64 v[16:17], v4 offset:32
  ds_read_b32 v20, v21 offset:56
  s_xor_b32 s73, s58, 71681
  s_add_u32 m0, m0, s76
  s_waitcnt vmcnt(22)
  buffer_load_dwordx4 v1, s[24:27], s73 offen nt lds
  s_xor_b32 s73, s58, 79873
  s_add_u32 m0, m0, s76
  s_waitcnt vmcnt(22)
  buffer_load_dwordx4 v1, s[24:27], s73 offen nt lds
  s_xor_b32 s73, s58, 38913
  s_add_u32 m0, m0, s76
  s_waitcnt vmcnt(22)
  buffer_load_dwordx4 v1, s[24:27], s73 offen nt lds
  s_waitcnt lgkmcnt(0)
  ds_read_b128 v[12:15], v4 offset:16
  v_mov_b32 v19, s70
  ds_write_b64 v4, v[18:19] offset:40
  s_xor_b32 s73, s58, 47105
  s_add_u32 m0, m0, s76
  s_waitcnt vmcnt(22)
  buffer_load_dwordx4 v1, s[24:27], s73 offen nt lds
  v_readfirstlane_b32 s54, v16
  v_readfirstlane_b32 s55, v17
  s_sub_u32 s72, s70, s54
  s_mul_i32 s55, s55, s52
  s_lshr_b32 s55, s55, 4
  s_cselect_b32 s72, s72, 0
  s_sub_u32 s72, s72, s55
  s_xor_b32 s73, s58, 104449
  s_add_u32 m0, m0, s76
  s_waitcnt vmcnt(22)
  buffer_load_dwordx4 v1, s[24:27], s73 offen nt lds
  v_add_u32 v7, 9, v18
  v_max_u32 v2, v2, v7
  ds_write_b32 v4, v2 offset:0
  s_xor_b32 s73, s58, 112641
  s_add_u32 m0, m0, s76
  s_waitcnt vmcnt(22)
  buffer_load_dwordx4 v1, s[24:27], s73 offen nt lds
  s_cbranch_execz L_up2b
  s_branch L_tail
L_up2:
L_up2b:
  s_xor_b32 s73, s58, 1
  s_mov_b32 m0, s59
  s_waitcnt vmcnt(24)
  buffer_load_dwordx4 v1, s[24:27], s73 offen nt lds
  v_add_u32 v7, 5, v18
  v_max_u32 v2, v2, v7
  ds_write_b32 v4, v2 offset:0
  s_xor_b32 s73, s58, 8193
  s_add_u32 m0, m0, s76
  s_waitcnt vmcnt(24)
  buffer_load_dwordx4 v1, s[24:27], s73 offen nt lds
  s_xor_b32 s73, s58, 65537
  s_add_u32 m0, m0, s76
  s_waitcnt vmcnt(24)
  buffer_load_dwordx4 v1, s[24:27], s73 offen nt lds
  s_xor_b32 s73, s58, 73729
  s_add_u32 m0, m0, s76
  s_waitcnt vmcnt(24)
  buffer_load_dwordx4 v1, s[24:27], s73 offen nt lds
  s_xor_b32 s73, s58, 32769
  s_add_u32 m0, m0, s76
  s_waitcnt vmcnt(24)
  buffer_load_dwordx4 v1, s[24:27], s73 offen nt lds
  s_xor_b32 s73, s58, 40961
  s_add_u32 m0, m0, s76
  s_waitcnt vmcnt(24)
  buffer_load_dwordx4 v1, s[24:27], s73 offen nt lds
  s_xor_b32 s73, s58, 98305
  s_add_u32 m0, m0, s76
  s_waitcnt vmcnt(24)
  buffer_load_dwordx4 v1, s[24:27], s73 offen nt lds
  s_xor_b32 s73, s58, 106497
  s_add_u32 m0, m0, s76
  s_waitcnt vmcnt(24)
  buffer_load_dwordx4 v1, s[24:27], s73 offen nt lds
  s_xor_b32 s73, s58, 4097
  s_add_u32 m0, m0, s76
  s_waitcnt vmcnt(24)
  buffer_load_dwordx4 v1, s[24:27], s73 offen nt lds
  v_add_u32 v7, 6, v18
  v_max_u32 v2, v2, v7
  ds_write_b32 v4, v2 offset:0
  s_xor_b32 s73, s58, 12289
  s_add_u32 m0, m0, s76
  s_waitcnt vmcnt(24)
  buffer_load_dwordx4 v1, s[24:27], s73 offen nt lds
  s_xor_b32 s73, s58, 69633
  s_add_u32 m0, m0, s76
  s_waitcnt vmcnt(24)
  buffer_load_dwordx4 v1, s[24:27], s73 offen nt lds
  s_xor_b32 s73, s58, 77825
  s_add_u32 m0, m0, s76
  s_waitcnt vmcnt(24)
  buffer_load_dwordx4 v1, s[24:27], s73 offen nt lds
  s_xor_b32 s73, s58, 36865
  s_add_u32 m0, m0, s76
  s_waitcnt vmcnt(24)
  buffer_load_dwordx4 v1, s[24:27], s73 offen nt lds
  s_xor_b32 s73, s58, 45057
  s_add_u32 m0, m0, s76
  s_waitcnt vmcnt(24)
  buffer_load_dwordx4 v1, s[24:27], s73 offen nt lds
  s_xor_b32 s73, s58, 102401
  s_add_u32 m0, m0, s76
  s_waitcnt vmcnt(24)
  buffer_load_dwordx4 v1, s[24:27], s73 offen nt lds
  s_xor_b32 s73, s58, 110593
  s_add_u32 m0, m0, s76
  s_waitcnt vmcnt(24)
  buffer_load_dwordx4 v1, s[24:27], s73 offen nt lds
  s_xor_b32 s73, s58, 2049
  s_add_u32 m0, m0, s76
  s_waitcnt vmcnt(24)
  buffer_load_dwordx4 v1, s[24:27], s73 offen nt lds
  v_add_u32 v7, 7, v18
  v_max_u32 v2, v2, v7
  ds_write_b32 v4, v2 offset:0
  s_xor_b32 s73, s58, 10241
  s_add_u32 m0, m0, s76
  s_waitcnt vmcnt(24)
  buffer_load_dwordx4 v1, s[24:27], s73 offen nt lds
  s_xor_b32 s73, s58, 67585
  s_add_u32 m0, m0, s76
  s_waitcnt vmcnt(24)
  buffer_load_dwordx4 v1, s[24:27], s73 offen nt lds
  s_xor_b32 s73, s58, 75777
  s_add_u32 m0, m0, s76
  s_waitcnt vmcnt(24)
  buffer_load_dwordx4 v1, s[24:27], s73 offen nt lds
  s_xor_b32 s73, s58, 34817
  s_add_u32 m0, m0, s76
  s_waitcnt vmcnt(24)
  buffer_load_dwordx4 v1, s[24:27], s73 offen nt lds
  s_xor_b32 s73, s58, 43009
  s_add_u32 m0, m0, s76
  s_waitcnt vmcnt(24)
  buffer_load_dwordx4 v1, s[24:27], s73 offen nt lds
  s_xor_b32 s73, s58, 100353
  s_add_u32 m0, m0, s76
  s_waitcnt vmcnt(24)
  buffer_load_dwordx4 v1, s[24:27], s73 offen nt lds
  s_xor_b32 s73, s58, 108545
  s_add_u32 m0, m0, s76
  s_waitcnt vmcnt(24)
  buffer_load_dwordx4 v1, s[24:27], s73 offen nt lds
  s_xor_b32 s73, s58, 6145
  s_add_u32 m0, m0, s76
  s_waitcnt vmcnt(24)
  buffer_load_dwordx4 v1, s[24:27], s73 offen nt lds
  v_add_u32 v7, 8, v18
  v_max_u32 v2, v2, v7
  ds_write_b32 v4, v2 offset:0
  s_xor_b32 s73, s58, 14337
  s_add_u32 m0, m0, s76
  s_waitcnt vmcnt(24)
  buffer_load_dwordx4 v1, s[24:27], s73 offen nt lds
  s_xor_b32 s73, s58, 71681
  s_add_u32 m0, m0, s76
  s_waitcnt vmcnt(24)
  buffer_load_dwordx4 v1, s[24:27], s73 offen nt lds
  s_xor_b32 s73, s58, 79873
  s_add_u32 m0, m0, s76
  s_waitcnt vmcnt(24)
  buffer_load_dwordx4 v1, s[24:27], s73 offen nt lds
  s_memrealtime s[70:71]
  ds_read_b64 v[16:17], v4 offset:32
  ds_read_b32 v20, v21 offset:56
  s_xor_b32 s73, s58, 38913
  s_add_u32 m0, m0, s76
  s_waitcnt vmcnt(24)
  buffer_load_dwordx4 v1, s[24:27], s73 offen nt lds
  s_waitcnt lgkmcnt(0)
  ds_read_b128 v[12:15], v4 offset:16
  v_mov_b32 v19, s70
  ds_write_b64 v4, v[18:19] offset:40
  s_xor_b32 s73, s58, 47105
  s_add_u32 m0, m0, s76
  s_waitcnt vmcnt(24)
  buffer_load_dwordx4 v1, s[24:27], s73 offen nt lds
  v_readfirstlane_b32 s54, v16
  v_readfirstlane_b32 s55, v17
  s_sub_u32 s72, s70, s54
  s_mul_i32 s55, s55, s52
  s_lshr_b32 s55, s55, 4
  s_cselect_b32 s72, s72, 0
  s_sub_u32 s72, s72, s55
  s_xor_b32 s73, s58, 104449
  s_add_u32 m0, m0, s76
  s_waitcnt vmcnt(24)
  buffer_load_dwordx4 v1, s[24:27], s73 offen nt lds
  s_xor_b32 s73, s58, 112641
  s_add_u32 m0, m0, s76
  s_waitcnt vmcnt(24)
  buffer_load_dwordx4 v1, s[24:27], s73 offen nt lds
  s_cbranch_execz L_fin
  s_branch L_tail
L_retry:
  ds_read_b32 v20, v21 offset:56
  s_waitcnt lgkmcnt(0)
  s_branch L_tail
L_half:
  s_mov_b32 s24, s8
  s_and_b32 s25, s9, 0xffff
  s_branch L_top
L_fin:
  s_xor_b32 s73, s58, 1
  s_add_u32 m0, s59, 0
  s_waitcnt vmcnt(22)
  buffer_load_dwordx4 v1, s[24:27], s73 offen nt lds
  v_max_u32 v2, 513, v2
  ds_write_b32 v4, v2 offset:0
  s_xor_b32 s73, s58, 8193
  s_add_u32 m0, m0, s76
  s_waitcnt vmcnt(22)
  buffer_load_dwordx4 v1, s[24:27], s73 offen nt lds
  s_xor_b32 s73, s58, 4097
  s_add_u32 m0, s59, 8192
  s_waitcnt vmcnt(22)
  buffer_load_dwordx4 v1, s[24:27], s73 offen nt lds
  s_xor_b32 s73, s58, 12289
  s_add_u32 m0, m0, s76
  s_waitcnt vmcnt(22)
  buffer_load_dwordx4 v1, s[24:27], s73 offen nt lds
  s_xor_b32 s73, s58, 2049
  s_add_u32 m0, s59, 16384
  s_waitcnt vmcnt(22)
  buffer_load_dwordx4 v1, s[24:27], s73 offen nt lds
  s_xor_b32 s73, s58, 10241
  s_add_u32 m0, m0, s76
  s_waitcnt vmcnt(22)
  buffer_load_dwordx4 v1, s[24:27], s73 offen nt lds
  s_xor_b32 s73, s58, 6145
  s_add_u32 m0, s59, 24576
  s_waitcnt vmcnt(22)
  buffer_load_dwordx4 v1, s[24:27], s73 offen nt lds
  v_max_u32 v2, 514, v2
  ds_write_b32 v4, v2 offset:0
  s_xor_b32 s73, s58, 14337
  s_add_u32 m0, m0, s76
  s_waitcnt vmcnt(22)
  buffer_load_dwordx4 v1, s[24:27], s73 offen nt lds
  s_xor_b32 s73, s58, 65537
  s_add_u32 m0, s59, 2048
  s_waitcnt vmcnt(22)
  buffer_load_dwordx4 v1, s[24:27], s73 offen nt lds
  s_xor_b32 s73, s58, 73729
  s_add_u32 m0, m0, s76
  s_waitcnt vmcnt(22)
  buffer_load_dwordx4 v1, s[24:27], s73 offen nt lds
  s_xor_b32 s73, s58, 69633
  s_add_u32 m0, s59, 10240
  s_waitcnt vmcnt(22)
  buffer_load_dwordx4 v1, s[24:27], s73 offen nt lds
  s_xor_b32 s73, s58, 77825
  s_add_u32 m0, m0, s76
  s_waitcnt vmcnt(22)
  buffer_load_dwordx4 v1, s[24:27], s73 offen nt lds
  s_xor_b32 s73, s58, 67585
  s_add_u32 m0, s59, 18432
  s_waitcnt vmcnt(22)
  buffer_load_dwordx4 v1, s[24:27], s73 offen nt lds
  s_xor_b32 s73, s58, 75777
  s_add_u32 m0, m0, s76
  s_waitcnt vmcnt(22)
  buffer_load_dwordx4 v1, s[24:27], s73 offen nt lds
  s_xor_b32 s73, s58, 71681
  s_add_u32 m0, s59, 26624
  s_waitcnt vmcnt(22)
  buffer_load_dwordx4 v1, s[24:27], s73 offen nt lds
  v_max_u32 v2, 515, v2
  ds_write_b32 v4, v2 offset:0
  s_xor_b32 s73, s58, 79873
  s_add_u32 m0, m0, s76
  s_waitcnt vmcnt(22)
  buffer_load_dwordx4 v1, s[24:27], s73 offen nt lds
  s_xor_b32 s73, s58, 32769
  s_add_u32 m0, s59, 4096
  s_waitcnt vmcnt(22)
  buffer_load_dwordx4 v1, s[24:27], s73 offen nt lds
  s_xor_b32 s73, s58, 40961
  s_add_u32 m0, m0, s76
  s_waitcnt vmcnt(22)
  buffer_load_dwordx4 v1, s[24:27], s73 offen nt lds
  s_xor_b32 s73, s58, 36865
  s_add_u32 m0, s59, 12288
  s_waitcnt vmcnt(22)
  buffer_load_dwordx4 v1, s[24:27], s73 offen nt lds
  s_xor_b32 s73, s58, 45057
  s_add_u32 m0, m0, s76
  s_waitcnt vmcnt(22)
  buffer_load_dwordx4 v1, s[24:27], s73 offen nt lds
  s_xor_b32 s73, s58, 34817
  s_add_u32 m0, s59, 20480
  s_waitcnt vmcnt(22)
  buffer_load_dwordx4 v1, s[24:27], s73 offen nt lds
  s_xor_b32 s73, s58, 43009
  s_add_u32 m0, m0, s76
  s_waitcnt vmcnt(22)
  buffer_load_dwordx4 v1, s[24:27], s73 offen nt lds
  s_xor_b32 s73, s58, 38913
  s_add_u32 m0, s59, 28672
  s_waitcnt vmcnt(22)
  buffer_load_dwordx4 v1, s[24:27], s73 offen nt lds
  v_max_u32 v2, 516, v2
  ds_write_b32 v4, v2 offset:0
  s_xor_b32 s73, s58, 47105
  s_add_u32 m0, m0, s76
  s_waitcnt vmcnt(22)
  buffer_load_dwordx4 v1, s[24:27], s73 offen nt lds
  s_xor_b32 s73, s58, 98305
  s_add_u32 m0, s59, 6144
  s_waitcnt vmcnt(22)
  buffer_load_dwordx4 v1, s[24:27], s73 offen nt lds
  v_max_u32 v2, 517, v2
  ds_write_b32 v4, v2 offset:0
  s_xor_b32 s73, s58, 106497
  s_add_u32 m0, m0, s76
  s_waitcnt vmcnt(22)
  buffer_load_dwordx4 v1, s[24:27], s73 offen nt lds
  s_xor_b32 s73, s58, 102401
  s_add_u32 m0, s59, 14336
  s_waitcnt vmcnt(22)
  buffer_load_dwordx4 v1, s[24:27], s73 offen nt lds
  v_max_u32 v2, 518, v2
  ds_write_b32 v4, v2 offset:0
  s_xor_b32 s73, s58, 110593
  s_add_u32 m0, m0, s76
  s_waitcnt vmcnt(22)
  buffer_load_dwordx4 v1, s[24:27], s73 offen nt lds
  s_xor_b32 s73, s58, 100353
  s_add_u32 m0, s59, 22528
  s_waitcnt vmcnt(22)
  buffer_load_dwordx4 v1, s[24:27], s73 offen nt lds
  v_max_u32 v2, 519, v2
  ds_write_b32 v4, v2 offset:0
  s_xor_b32 s73, s58, 108545
  s_add_u32 m0, m0, s76
  s_waitcnt vmcnt(22)
  buffer_load_dwordx4 v1, s[24:27], s73 offen nt lds
  s_xor_b32 s73, s58, 104449
  s_add_u32 m0, s59, 30720
  s_waitcnt vmcnt(22)
  buffer_load_dwordx4 v1, s[24:27], s73 offen nt lds
  v_max_u32 v2, 520, v2
  ds_write_b32 v4, v2 offset:0
  s_xor_b32 s73, s58, 112641
  s_add_u32 m0, m0, s76
  s_waitcnt vmcnt(22)
  buffer_load_dwordx4 v1, s[24:27], s73 offen nt lds
  s_cbranch_execz L_end2
L_drain:
  v_max_u32 v2, 521, v2
  s_waitcnt vmcnt(22)
  ds_write_b32 v4, v2 offset:0
  v_max_u32 v2, 522, v2
  s_waitcnt vmcnt(20)
  ds_write_b32 v4, v2 offset:0
  v_max_u32 v2, 523, v2
  s_waitcnt vmcnt(18)
  ds_write_b32 v4, v2 offset:0
  v_max_u32 v2, 524, v2
  s_waitcnt vmcnt(16)
  ds_write_b32 v4, v2 offset:0
  v_max_u32 v2, 525, v2
  s_waitcnt vmcnt(14)
  ds_write_b32 v4, v2 offset:0
  v_max_u32 v2, 526, v2
  s_waitcnt vmcnt(12)
  ds_write_b32 v4, v2 offset:0
  v_max_u32 v2, 527, v2
  s_waitcnt vmcnt(10)
  ds_write_b32 v4, v2 offset:0
  v_max_u32 v2, 528, v2
  s_waitcnt vmcnt(8)
  ds_write_b32 v4, v2 offset:0
  v_max_u32 v2, 529, v2
  s_waitcnt vmcnt(6)
  ds_write_b32 v4, v2 offset:0
  v_max_u32 v2, 530, v2
  s_waitcnt vmcnt(4)
  ds_write_b32 v4, v2 offset:0
  v_max_u32 v2, 531, v2
  s_waitcnt vmcnt(2)
  ds_write_b32 v4, v2 offset:0
  v_max_u32 v2, 532, v2
  s_waitcnt vmcnt(0)
  ds_write_b32 v4, v2 offset:0
  s_waitcnt lgkmcnt(0)
  s_cbranch_execz L_last
  s_endpgm
L_cons:
  s_mov_b32 s47, 0x3fb8aa3b
  v_and_b32 v97, 31, v96
  v_lshrrev_b32 v98, 5, v96
  s_lshl_b32 s54, s3, 5
  s_add_u32 s54, s54, 114688
  v_mov_b32 v1, s54
  s_lshl_b32 s54, s3, 13
  v_lshlrev_b32 v0, 4, v96
  v_add_u32 v0, s54, v0
  v_mov_b32 v23, v0
  s_mov_b32 s58, 0
  s_mov_b32 s54, 0x0202
  v_mul_lo_u32 v25, v98, s54
  v_lshlrev_b32 v24, 16, v25
  v_add_u32 v25, 0x0c0c0100, v25
  v_add_u32 v24, 0x01000c0c, v24
  v_lshlrev_b32 v97, 3, v97
  s_lshl_b32 s54, s48, 9
  v_add_u32 v97, s54, v97
  s_bfe_u32 s54, s75, 0x10017
  s_lshl_b32 s54, s54, 8
  v_add_u32 v26, s54, v97
  s_mov_b32 s40, 0xffff0000
  s_mov_b32 s42, 0xaaaaaaaa
  s_mov_b32 s43, 0xaaaaaaaa
  s_mov_b32 s44, 0x00f0000f
  s_mov_b32 s45, 0x00f0000f
  s_mov_b32 s46, 0x3db504f3
  s_lshl_b32 s55, s3, 7
  s_add_u32 s55, s55, 131456
  v_bfe_u32 v99, v96, 4, 2
  v_lshlrev_b32 v99, 5, v99
  v_and_b32 v100, 1, v96
  v_lshl_add_u32 v99, v100, 3, v99
  v_lshlrev_b32 v21, 1, v100
  v_bfe_u32 v100, v96, 3, 1
  v_lshl_add_u32 v99, v100, 1, v99
  v_bfe_u32 v100, v96, 2, 1
  v_lshl_add_u32 v99, v100, 2, v99
  v_add_u32 v2, s55, v99
  v_and_b32 v100, 3, v96
  v_lshl_add_u32 v99, v98, 2, v100
  v_lshlrev_b32 v99, 4, v99
  v_add_u32 v3, s55, v99
  v_and_b32 v100, 0x3c, v96
  v_add_u32 v21, v21, v100
  s_lshl_b32 s55, s3, 6
  v_add_u32 v21, s55, v21
  v_add_u32 v21, 98304, v21
  v_mov_b32 v20, v21
  v_mov_b32 v22, 0
  s_lshl_b32 s55, s3, 2
  s_add_u32 s55, s55, 131072
  v_mov_b32 v5, s55
  v_mov_b32 v6, 0xff800000
  v_mov_b32 v7, 0
  v_mov_b32 v101, 0
  s_add_u32 s50, s3, 9
  s_mov_b32 s52, 0
  s_mov_b64 s[36:37], 0
  s_movk_i32 s59, 127
  s_waitcnt lgkmcnt(0)
  global_load_dwordx2 v[16:17], v97, s[4:5] nt
  global_load_dwordx2 v[18:19], v97, s[4:5] offset:256 nt
  global_load_dwordx2 v[42:43], v26, s[10:11] nt
  global_load_dwordx2 v[44:45], v26, s[12:13] nt
  v_mov_b32 v76, 0
  v_mov_b32 v77, 0
  v_mov_b32 v78, 0
  v_mov_b32 v79, 0
  v_mov_b32 v80, 0
  v_mov_b32 v81, 0
  v_mov_b32 v82, 0
  v_mov_b32 v83, 0
  v_mov_b32 v84, 0
  v_mov_b32 v85, 0
  v_mov_b32 v86, 0
  v_mov_b32 v87, 0
  v_mov_b32 v88, 0
  v_mov_b32 v89, 0
  v_mov_b32 v90, 0
  v_mov_b32 v91, 0
  v_mov_b32 v92, 0
  v_mov_b32 v93, 0
  v_mov_b32 v94, 0
  v_mov_b32 v95, 0
  s_waitcnt vmcnt(0)
  v_and_b32 v12, 0xffff, v42
  v_and_b32 v13, s40, v42
  v_lshlrev_b32 v8, 16, v44
  v_and_b32 v9, s40, v44
  v_and_b32 v14, 0xffff, v43
  v_and_b32 v15, s40, v43
  v_lshlrev_b32 v10, 16, v45
  v_and_b32 v11, s40, v45
  s_branch L_k
L_kw:
  s_sleep 1
L_k:
  ds_read_b32 v103, v4 offset:0
  s_waitcnt lgkmcnt(0)
  v_readfirstlane_b32 s54, v103
  s_nop 0
  s_cmp_lt_u32 s54, s50
  s_cbranch_scc1 L_kw
  ds_read_b128 v[104:107], v0 offset:0
  ds_read_b128 v[108:111], v0 offset:1024
  ds_read_b128 v[112:115], v0 offset:2048
  ds_read_b128 v[116:119], v0 offset:3072
  ds_read_b128 v[120:123], v0 offset:4096
  ds_read_b128 v[124:127], v0 offset:5120
  ds_read_b128 v[128:131], v0 offset:6144
  ds_read_b128 v[132:135], v0 offset:7168
  s_add_u32 s58, s58, 32768
  s_cmp_eq_u32 s58, 98304
  s_cselect_b32 s58, 0, s58
  v_add_u32 v0, s58, v23
  s_add_u32 s50, s50, 4
  s_add_u32 s52, s52, 1
  s_waitcnt lgkmcnt(7)
  v_cvt_f32_i32 v36, v104
  v_cvt_f32_i32 v37, v105
  v_cvt_f32_i32 v38, v106
  v_cvt_f32_i32 v39, v107
  v_pk_add_f32 v[36:37], v[36:37], v[8:9] neg_lo:[0,1] neg_hi:[0,1]
  v_pk_add_f32 v[38:39], v[38:39], v[10:11] neg_lo:[0,1] neg_hi:[0,1]
  v_cvt_pk_bf16_f32 v40, v36, v37
  v_cvt_pk_bf16_f32 v41, v38, v39
  v_dot2_f32_bf16 v36, v40, v12, 0
  v_dot2_f32_bf16 v37, v40, v13, 0
  v_dot2_f32_bf16 v38, v41, v14, 0
  v_dot2_f32_bf16 v39, v41, v15, 0
  s_nop 0
  v_cvt_pk_bf16_f32 v56, v36, v37
  s_nop 0
  v_cvt_pk_bf16_f32 v57, v38, v39
  s_waitcnt lgkmcnt(6)
  v_cvt_f32_i32 v36, v108
  v_cvt_f32_i32 v37, v109
  v_cvt_f32_i32 v38, v110
  v_cvt_f32_i32 v39, v111
  v_pk_add_f32 v[36:37], v[36:37], v[8:9] neg_lo:[0,1] neg_hi:[0,1]
  v_pk_add_f32 v[38:39], v[38:39], v[10:11] neg_lo:[0,1] neg_hi:[0,1]
  v_cvt_pk_bf16_f32 v40, v36, v37
  v_cvt_pk_bf16_f32 v41, v38, v39
  v_dot2_f32_bf16 v36, v40, v12, 0
  v_dot2_f32_bf16 v37, v40, v13, 0
  v_dot2_f32_bf16 v38, v41, v14, 0
  v_dot2_f32_bf16 v39, v41, v15, 0
  v_dot2_f32_bf16 v42, v56, v16, 0
  v_dot2_f32_bf16 v43, v56, v18, 0
  v_dot2_f32_bf16 v42, v57, v17, v42
  v_dot2_f32_bf16 v43, v57, v19, v43
  v_cvt_pk_bf16_f32 v56, v36, v37
  v_cvt_pk_bf16_f32 v57, v38, v39
  s_waitcnt lgkmcnt(0)
  v_add_u32 v101, 1, v101
  ds_write_b32 v5, v101 offset:16
  v_cvt_f32_i32 v36, v112
  v_cvt_f32_i32 v37, v113
  v_cvt_f32_i32 v38, v114
  v_cvt_f32_i32 v39, v115
  v_pk_add_f32 v[36:37], v[36:37], v[8:9] neg_lo:[0,1] neg_hi:[0,1]
  v_pk_add_f32 v[38:39], v[38:39], v[10:11] neg_lo:[0,1] neg_hi:[0,1]
  v_cvt_pk_bf16_f32 v40, v36, v37
  v_cvt_pk_bf16_f32 v41, v38, v39
  v_dot2_f32_bf16 v36, v40, v12, 0
  v_dot2_f32_bf16 v37, v40, v13, 0
  v_dot2_f32_bf16 v38, v41, v14, 0
  v_dot2_f32_bf16 v39, v41, v15, 0
  v_dot2_f32_bf16 v44, v56, v16, 0
  v_dot2_f32_bf16 v45, v56, v18, 0
  v_dot2_f32_bf16 v44, v57, v17, v44
  v_dot2_f32_bf16 v45, v57, v19, v45
  v_cvt_pk_bf16_f32 v56, v36, v37
  v_cvt_pk_bf16_f32 v57, v38, v39
  v_cvt_f32_i32 v36, v116
  v_cvt_f32_i32 v37, v117
  v_cvt_f32_i32 v38, v118
  v_cvt_f32_i32 v39, v119
  v_pk_add_f32 v[36:37], v[36:37], v[8:9] neg_lo:[0,1] neg_hi:[0,1]
  v_pk_add_f32 v[38:39], v[38:39], v[10:11] neg_lo:[0,1] neg_hi:[0,1]
  v_cvt_pk_bf16_f32 v40, v36, v37
  v_cvt_pk_bf16_f32 v41, v38, v39
  v_dot2_f32_bf16 v36, v40, v12, 0
  v_dot2_f32_bf16 v37, v40, v13, 0
  v_dot2_f32_bf16 v38, v41, v14, 0
  v_dot2_f32_bf16 v39, v41, v15, 0
  v_dot2_f32_bf16 v46, v56, v16, 0
  v_dot2_f32_bf16 v47, v56, v18, 0
  v_dot2_f32_bf16 v46, v57, v17, v46
  v_dot2_f32_bf16 v47, v57, v19, v47
  v_cvt_pk_bf16_f32 v56, v36, v37
  v_cvt_pk_bf16_f32 v57, v38, v39
  v_cvt_f32_i32 v36, v120
  v_cvt_f32_i32 v37, v121
  v_cvt_f32_i32 v38, v122
  v_cvt_f32_i32 v39, v123
  v_pk_add_f32 v[36:37], v[36:37], v[8:9] neg_lo:[0,1] neg_hi:[0,1]
  v_pk_add_f32 v[38:39], v[38:39], v[10:11] neg_lo:[0,1] neg_hi:[0,1]
  v_cvt_pk_bf16_f32 v40, v36, v37
  v_cvt_pk_bf16_f32 v41, v38, v39
  v_dot2_f32_bf16 v36, v40, v12, 0
  v_dot2_f32_bf16 v37, v40, v13, 0
  v_dot2_f32_bf16 v38, v41, v14, 0
  v_dot2_f32_bf16 v39, v41, v15, 0
  v_dot2_f32_bf16 v48, v56, v16, 0
  v_dot2_f32_bf16 v49, v56, v18, 0
  v_dot2_f32_bf16 v48, v57, v17, v48
  v_dot2_f32_bf16 v49, v57, v19, v49
  v_cvt_pk_bf16_f32 v56, v36, v37
  v_cvt_pk_bf16_f32 v57, v38, v39
  v_permlane16_swap_b32 v42, v43
  v_permlane16_swap_b32 v44, v45
  v_permlane16_swap_b32 v46, v47
  v_permlane16_swap_b32 v48, v49
  v_add_f32 v42, v42, v43
  v_add_f32 v44, v44, v45
  v_add_f32 v46, v46, v47
  v_add_f32 v48, v48, v49
  v_add_f32_dpp v50, v42, v42 row_mirror row_mask:0xf bank_mask:0x3
  v_add_f32_dpp v51, v46, v46 row_mirror row_mask:0xf bank_mask:0x3
  s_nop 0
  v_add_f32_dpp v50, v44, v44 row_mirror row_mask:0xf bank_mask:0xc
  v_add_f32_dpp v51, v48, v48 row_mirror row_mask:0xf bank_mask:0xc
  s_nop 0
  v_add_f32_dpp v52, v50, v50 row_half_mirror row_mask:0xf bank_mask:0x5
  s_nop 1
  v_add_f32_dpp v52, v51, v51 row_half_mirror row_mask:0xf bank_mask:0xa
  v_cvt_f32_i32 v36, v124
  v_cvt_f32_i32 v37, v125
  v_cvt_f32_i32 v38, v126
  v_cvt_f32_i32 v39, v127
  v_pk_add_f32 v[36:37], v[36:37], v[8:9] neg_lo:[0,1] neg_hi:[0,1]
  v_pk_add_f32 v[38:39], v[38:39], v[10:11] neg_lo:[0,1] neg_hi:[0,1]
  v_cvt_pk_bf16_f32 v40, v36, v37
  v_cvt_pk_bf16_f32 v41, v38, v39
  v_dot2_f32_bf16 v36, v40, v12, 0
  v_dot2_f32_bf16 v37, v40, v13, 0
  v_dot2_f32_bf16 v38, v41, v14, 0
  v_dot2_f32_bf16 v39, v41, v15, 0
  v_dot2_f32_bf16 v42, v56, v16, 0
  v_dot2_f32_bf16 v43, v56, v18, 0
  v_dot2_f32_bf16 v42, v57, v17, v42
  v_dot2_f32_bf16 v43, v57, v19, v43
  v_cvt_pk_bf16_f32 v56, v36, v37
  v_cvt_pk_bf16_f32 v57, v38, v39
  v_cvt_f32_i32 v36, v128
  v_cvt_f32_i32 v37, v129
  v_cvt_f32_i32 v38, v130
  v_cvt_f32_i32 v39, v131
  v_pk_add_f32 v[36:37], v[36:37], v[8:9] neg_lo:[0,1] neg_hi:[0,1]
  v_pk_add_f32 v[38:39], v[38:39], v[10:11] neg_lo:[0,1] neg_hi:[0,1]
  v_cvt_pk_bf16_f32 v40, v36, v37
  v_cvt_pk_bf16_f32 v41, v38, v39
  v_dot2_f32_bf16 v36, v40, v12, 0
  v_dot2_f32_bf16 v37, v40, v13, 0
  v_dot2_f32_bf16 v38, v41, v14, 0
  v_dot2_f32_bf16 v39, v41, v15, 0
  v_dot2_f32_bf16 v44, v56, v16, 0
  v_dot2_f32_bf16 v45, v56, v18, 0
  v_dot2_f32_bf16 v44, v57, v17, v44
  v_dot2_f32_bf16 v45, v57, v19, v45
  v_cvt_pk_bf16_f32 v56, v36, v37
  v_cvt_pk_bf16_f32 v57, v38, v39
  v_cvt_f32_i32 v36, v132
  v_cvt_f32_i32 v37, v133
  v_cvt_f32_i32 v38, v134
  v_cvt_f32_i32 v39, v135
  v_pk_add_f32 v[36:37], v[36:37], v[8:9] neg_lo:[0,1] neg_hi:[0,1]
  v_pk_add_f32 v[38:39], v[38:39], v[10:11] neg_lo:[0,1] neg_hi:[0,1]
  v_cvt_pk_bf16_f32 v40, v36, v37
  v_cvt_pk_bf16_f32 v41, v38, v39
  v_dot2_f32_bf16 v36, v40, v12, 0
  v_dot2_f32_bf16 v37, v40, v13, 0
  v_dot2_f32_bf16 v38, v41, v14, 0
  v_dot2_f32_bf16 v39, v41, v15, 0
  v_dot2_f32_bf16 v46, v56, v16, 0
  v_dot2_f32_bf16 v47, v56, v18, 0
  v_dot2_f32_bf16 v46, v57, v17, v46
  v_dot2_f32_bf16 v47, v57, v19, v47
  v_cvt_pk_bf16_f32 v56, v36, v37
  v_cvt_pk_bf16_f32 v57, v38, v39
  v_dot2_f32_bf16 v48, v56, v16, 0
  v_dot2_f32_bf16 v49, v56, v18, 0
  v_dot2_f32_bf16 v48, v57, v17, v48
  v_dot2_f32_bf16 v49, v57, v19, v49
  v_permlane16_swap_b32 v42, v43
  v_permlane16_swap_b32 v44, v45
  v_permlane16_swap_b32 v46, v47
  v_permlane16_swap_b32 v48, v49
  v_add_f32 v42, v42, v43
  v_add_f32 v44, v44, v45
  v_add_f32 v46, v46, v47
  v_add_f32 v48, v48, v49
  v_add_f32_dpp v50, v42, v42 row_mirror row_mask:0xf bank_mask:0x3
  v_add_f32_dpp v51, v46, v46 row_mirror row_mask:0xf bank_mask:0x3
  s_nop 0
  v_add_f32_dpp v50, v44, v44 row_mirror row_mask:0xf bank_mask:0xc
  v_add_f32_dpp v51, v48, v48 row_mirror row_mask:0xf bank_mask:0xc
  s_nop 0
  v_add_f32_dpp v53, v50, v50 row_half_mirror row_mask:0xf bank_mask:0x5
  s_nop 1
  v_add_f32_dpp v53, v51, v51 row_half_mirror row_mask:0xf bank_mask:0xa
  v_cndmask_b32 v54, v53, v52, s[42:43]
  v_cndmask_b32 v55, v52, v53, s[42:43]
  s_nop 1
  v_add_f32_dpp v50, v54, v55 quad_perm:[1,0,3,2] row_mask:0xf bank_mask:0xf
  s_nop 1
  v_add_f32_dpp v50, v50, v50 quad_perm:[2,3,0,1] row_mask:0xf bank_mask:0xf
  v_cvt_pk_bf16_f32 v50, v50, v50
  v_lshlrev_b32 v50, 16, v50
  v_mul_f32 v50, s46, v50
  v_cvt_pk_bf16_f32 v50, v50, v50
  ds_write_b16 v20, v50
  v_and_b32 v51, s40, v50
  v_max_f32 v6, v6, v51
  v_add_u32 v20, 0x100, v20
  s_cmp_lt_u32 s52, 64
  s_cbranch_scc1 L_k
  v_max_f32_dpp v6, v6, v6 quad_perm:[1,0,3,2] row_mask:0xf bank_mask:0xf
  s_nop 1
  v_max_f32_dpp v6, v6, v6 row_half_mirror row_mask:0xf bank_mask:0xf
  s_nop 1
  v_max_f32_dpp v6, v6, v6 row_mirror row_mask:0xf bank_mask:0xf
  v_mov_b32 v97, v6
  s_nop 1
  v_permlane32_swap_b32 v6, v97
  v_max_f32 v6, v6, v97
  v_bfe_u32 v99, v96, 4, 1
  v_lshl_add_u32 v100, v99, 4, v5
  v_lshl_add_u32 v99, v99, 4, v4
  ds_write_b32 v100, v6 offset:320
  v_mov_b32 v97, 1
  s_mov_b64 exec, 1
  ds_add_u32 v4, v97 offset:4
  s_mov_b64 exec, -1
L_kd:
  ds_read_b32 v103, v4 offset:4
  ds_read_b128 v[36:39], v99 offset:320
  s_waitcnt lgkmcnt(0)
  v_readfirstlane_b32 s54, v103
  s_nop 0
  s_cmp_ge_u32 s54, 5
  s_cbranch_scc1 L_kd1
  s_sleep 2
  s_branch L_kd
L_kd1:
  v_max3_f32 v6, v36, v37, v38
  v_max_f32 v6, v6, v39
L_v:
  ds_read_u16_d16_hi v22, v21
  ds_read_b128 v[36:39], v1
  ds_read_b128 v[40:43], v1 offset:16
  ds_read_b128 v[44:47], v1 offset:8192
  ds_read_b128 v[48:51], v1 offset:8208
  v_add_u32 v21, 0x100, v21
  v_add_u32 v1, 0x80, v1
  s_waitcnt lgkmcnt(4)
  v_sub_f32 v97, v22, v6
  v_mul_f32 v97, s47, v97
  v_exp_f32 v97, v97
  s_nop 0
  v_add_f32 v7, v7, v97
  v_cvt_pk_bf16_f32 v98, v97, v97
  v_lshlrev_b32 v98, 16, v98
  v_sub_f32 v98, v97, v98
  v_cvt_pk_bf16_f32 v98, v97, v98
  ds_write_b16 v2, v98
  ds_write_b16_d16_hi v2, v98 offset:16
  s_mov_b64 exec, s[44:45]
  ds_read_b128 v[92:95], v3
  s_mov_b64 exec, -1
  s_waitcnt lgkmcnt(3)
  v_perm_b32 v36, v36, v36, v24
  v_perm_b32 v37, v37, v37, v24
  v_perm_b32 v38, v38, v38, v24
  v_perm_b32 v39, v39, v39, v24
  v_perm_b32 v40, v40, v40, v24
  v_perm_b32 v41, v41, v41, v24
  v_perm_b32 v42, v42, v42, v24
  v_perm_b32 v43, v43, v43, v24
  v_perm_b32 v44, v44, v44, v25
  v_perm_b32 v45, v45, v45, v24
  v_perm_b32 v46, v46, v46, v25
  v_perm_b32 v47, v47, v47, v24
  v_perm_b32 v48, v48, v48, v25
  v_perm_b32 v49, v49, v49, v24
  v_perm_b32 v50, v50, v50, v25
  v_perm_b32 v51, v51, v51, v24
  s_cmp_eq_u32 s52, s59
  s_cbranch_scc1 L_last
  s_branch L_vp
L_vpw:
  s_sleep 1
L_vp:
  ds_read_b32 v103, v4 offset:0
  s_waitcnt lgkmcnt(0)
  v_readfirstlane_b32 s54, v103
  s_nop 0
  s_cmp_lt_u32 s54, s50
  s_cbranch_scc1 L_vpw
  ds_read_b128 v[104:107], v0 offset:0
  ds_read_b128 v[108:111], v0 offset:1024
  ds_read_b128 v[112:115], v0 offset:2048
  ds_read_b128 v[116:119], v0 offset:3072
  ds_read_b128 v[120:123], v0 offset:4096
  ds_read_b128 v[124:127], v0 offset:5120
  ds_read_b128 v[128:131], v0 offset:6144
  ds_read_b128 v[132:135], v0 offset:7168
  s_add_u32 s58, s58, 32768
  s_cmp_eq_u32 s58, 98304
  s_cselect_b32 s58, 0, s58
  v_add_u32 v0, s58, v23
  s_add_u32 s50, s50, 4
  s_add_u32 s52, s52, 1
  s_waitcnt lgkmcnt(6)
  v_cvt_f32_i32 v52, v104
  v_cvt_f32_i32 v54, v105
  v_cvt_f32_i32 v56, v106
  v_cvt_f32_i32 v58, v107
  v_cvt_f32_i32 v53, v108
  v_cvt_f32_i32 v55, v109
  v_cvt_f32_i32 v57, v110
  v_cvt_f32_i32 v59, v111
  v_pk_add_f32 v[52:53], v[52:53], v[36:37] neg_lo:[0,1] neg_hi:[0,1]
  v_pk_add_f32 v[54:55], v[54:55], v[36:37] neg_lo:[0,1] neg_hi:[0,1]
  v_pk_add_f32 v[56:57], v[56:57], v[36:37] neg_lo:[0,1] neg_hi:[0,1]
  v_pk_add_f32 v[58:59], v[58:59], v[36:37] neg_lo:[0,1] neg_hi:[0,1]
  v_cvt_pk_bf16_f32 v60, v52, v53
  v_cvt_pk_bf16_f32 v64, v54, v55
  v_cvt_pk_bf16_f32 v68, v56, v57
  v_cvt_pk_bf16_f32 v72, v58, v59
  v_dot2_f32_bf16 v52, v60, v44, 0
  v_dot2_f32_bf16 v53, v60, v45, 0
  v_dot2_f32_bf16 v54, v64, v44, 0
  v_dot2_f32_bf16 v55, v64, v45, 0
  v_dot2_f32_bf16 v56, v68, v44, 0
  v_dot2_f32_bf16 v57, v68, v45, 0
  v_dot2_f32_bf16 v58, v72, v44, 0
  v_dot2_f32_bf16 v59, v72, v45, 0
  v_cvt_pk_bf16_f32 v60, v52, v53
  v_cvt_pk_bf16_f32 v64, v54, v55
  v_cvt_pk_bf16_f32 v68, v56, v57
  v_cvt_pk_bf16_f32 v72, v58, v59
  s_waitcnt lgkmcnt(0)
  v_add_u32 v101, 1, v101
  ds_write_b32 v5, v101 offset:16
  v_cvt_f32_i32 v52, v112
  v_cvt_f32_i32 v54, v113
  v_cvt_f32_i32 v56, v114
  v_cvt_f32_i32 v58, v115
  v_cvt_f32_i32 v53, v116
  v_cvt_f32_i32 v55, v117
  v_cvt_f32_i32 v57, v118
  v_cvt_f32_i32 v59, v119
  v_pk_add_f32 v[52:53], v[52:53], v[38:39] neg_lo:[0,1] neg_hi:[0,1]
  v_pk_add_f32 v[54:55], v[54:55], v[38:39] neg_lo:[0,1] neg_hi:[0,1]
  v_pk_add_f32 v[56:57], v[56:57], v[38:39] neg_lo:[0,1] neg_hi:[0,1]
  v_pk_add_f32 v[58:59], v[58:59], v[38:39] neg_lo:[0,1] neg_hi:[0,1]
  v_cvt_pk_bf16_f32 v61, v52, v53
  v_cvt_pk_bf16_f32 v65, v54, v55
  v_cvt_pk_bf16_f32 v69, v56, v57
  v_cvt_pk_bf16_f32 v73, v58, v59
  v_dot2_f32_bf16 v52, v61, v46, 0
  v_dot2_f32_bf16 v53, v61, v47, 0
  v_dot2_f32_bf16 v54, v65, v46, 0
  v_dot2_f32_bf16 v55, v65, v47, 0
  v_dot2_f32_bf16 v56, v69, v46, 0
  v_dot2_f32_bf16 v57, v69, v47, 0
  v_dot2_f32_bf16 v58, v73, v46, 0
  v_dot2_f32_bf16 v59, v73, v47, 0
  v_cvt_pk_bf16_f32 v61, v52, v53
  v_cvt_pk_bf16_f32 v65, v54, v55
  v_cvt_pk_bf16_f32 v69, v56, v57
  v_cvt_pk_bf16_f32 v73, v58, v59
  v_cvt_f32_i32 v52, v120
  v_cvt_f32_i32 v54, v121
  v_cvt_f32_i32 v56, v122
  v_cvt_f32_i32 v58, v123
  v_cvt_f32_i32 v53, v124
  v_cvt_f32_i32 v55, v125
  v_cvt_f32_i32 v57, v126
  v_cvt_f32_i32 v59, v127
  v_pk_add_f32 v[52:53], v[52:53], v[40:41] neg_lo:[0,1] neg_hi:[0,1]
  v_pk_add_f32 v[54:55], v[54:55], v[40:41] neg_lo:[0,1] neg_hi:[0,1]
  v_pk_add_f32 v[56:57], v[56:57], v[40:41] neg_lo:[0,1] neg_hi:[0,1]
  v_pk_add_f32 v[58:59], v[58:59], v[40:41] neg_lo:[0,1] neg_hi:[0,1]
  v_cvt_pk_bf16_f32 v62, v52, v53
  v_cvt_pk_bf16_f32 v66, v54, v55
  v_cvt_pk_bf16_f32 v70, v56, v57
  v_cvt_pk_bf16_f32 v74, v58, v59
  v_dot2_f32_bf16 v52, v62, v48, 0
  v_dot2_f32_bf16 v53, v62, v49, 0
  v_dot2_f32_bf16 v54, v66, v48, 0
  v_dot2_f32_bf16 v55, v66, v49, 0
  v_dot2_f32_bf16 v56, v70, v48, 0
  v_dot2_f32_bf16 v57, v70, v49, 0
  v_dot2_f32_bf16 v58, v74, v48, 0
  v_dot2_f32_bf16 v59, v74, v49, 0
  v_cvt_pk_bf16_f32 v62, v52, v53
  v_cvt_pk_bf16_f32 v66, v54, v55
  v_cvt_pk_bf16_f32 v70, v56, v57
  v_cvt_pk_bf16_f32 v74, v58, v59
  v_cvt_f32_i32 v52, v128
  v_cvt_f32_i32 v54, v129
  v_cvt_f32_i32 v56, v130
  v_cvt_f32_i32 v58, v131
  v_cvt_f32_i32 v53, v132
  v_cvt_f32_i32 v55, v133
  v_cvt_f32_i32 v57, v134
  v_cvt_f32_i32 v59, v135
  v_pk_add_f32 v[52:53], v[52:53], v[42:43] neg_lo:[0,1] neg_hi:[0,1]
  v_pk_add_f32 v[54:55], v[54:55], v[42:43] neg_lo:[0,1] neg_hi:[0,1]
  v_pk_add_f32 v[56:57], v[56:57], v[42:43] neg_lo:[0,1] neg_hi:[0,1]
  v_pk_add_f32 v[58:59], v[58:59], v[42:43] neg_lo:[0,1] neg_hi:[0,1]
  v_cvt_pk_bf16_f32 v63, v52, v53
  v_cvt_pk_bf16_f32 v67, v54, v55
  v_cvt_pk_bf16_f32 v71, v56, v57
  v_cvt_pk_bf16_f32 v75, v58, v59
  v_dot2_f32_bf16 v52, v63, v50, 0
  v_dot2_f32_bf16 v53, v63, v51, 0
  v_dot2_f32_bf16 v54, v67, v50, 0
  v_dot2_f32_bf16 v55, v67, v51, 0
  v_dot2_f32_bf16 v56, v71, v50, 0
  v_dot2_f32_bf16 v57, v71, v51, 0
  v_dot2_f32_bf16 v58, v75, v50, 0
  v_dot2_f32_bf16 v59, v75, v51, 0
  v_cvt_pk_bf16_f32 v63, v52, v53
  v_cvt_pk_bf16_f32 v67, v54, v55
  v_cvt_pk_bf16_f32 v71, v56, v57
  v_cvt_pk_bf16_f32 v75, v58, v59
  v_mfma_f32_16x16x32_bf16 v[76:79], v[92:95], v[60:63], v[76:79]
  v_mfma_f32_16x16x32_bf16 v[80:83], v[92:95], v[64:67], v[80:83]
  v_mfma_f32_16x16x32_bf16 v[84:87], v[92:95], v[68:71], v[84:87]
  v_mfma_f32_16x16x32_bf16 v[88:91], v[92:95], v[72:75], v[88:91]
  s_branch L_v
L_last:
  v_add_f32_dpp v7, v7, v7 quad_perm:[1,0,3,2] row_mask:0xf bank_mask:0xf
  s_nop 1
  v_add_f32_dpp v7, v7, v7 row_half_mirror row_mask:0xf bank_mask:0xf
  s_nop 1
  v_add_f32_dpp v7, v7, v7 row_mirror row_mask:0xf bank_mask:0xf
  v_mov_b32 v97, v7
  s_nop 1
  v_permlane32_swap_b32 v7, v97
  v_add_f32 v7, v7, v97
  ds_write_b32 v100, v7 offset:352
  v_lshlrev_b32 v98, 4, v96
  v_add_u32 v99, 98304, v98
  s_lshl_b32 s54, s3, 10
  v_add_u32 v97, s54, v99
  v_mov_b32 v101, 129
  v_lshrrev_b32 v100, 5, v96
  v_lshlrev_b32 v102, 4, v100
  s_mov_b32 s44, 1
  s_mov_b32 s45, 1
  s_and_b64 s[44:45], s[44:45], exec
  s_mov_b64 s[42:43], exec
  s_mov_b32 s61, 0x07060501
  s_mov_b32 s62, 0x07060502
  s_mov_b32 s63, 0x07060503
  s_mov_b32 s38, 0x04000c0c
  s_mov_b32 s39, 0x0706000c
  v_lshl_add_u32 v100, v100, 4, v4
  ds_read_b128 v[16:19], v100 offset:320
  s_mov_b32 s24, s22
  s_and_b32 s25, s23, 0xffff
  s_mov_b32 s26, 524288
  s_mov_b32 s27, 0x00020000
  s_mov_b32 s28, s18
  s_and_b32 s29, s19, 0xffff
  s_mov_b32 s30, 16384
  s_mov_b32 s31, 0x00020000
  s_lshl_b32 s56, s2, 10
  s_lshl_b32 s46, s2, 5
  s_bitset1_b32 s46, 18
  v_and_b32 v20, 7, v96
  v_lshl_add_u32 v20, v20, 5, v102
  v_lshrrev_b32 v21, 1, v98
  s_lshl_b32 s55, s48, 9
  s_mov_b32 s60, 1048576
  s_or_b32 s53, s53, 16
  s_waitcnt lgkmcnt(0)
  v_max3_f32 v10, v16, v17, v18
  v_max_f32 v10, v10, v19
L_r0:
  ds_read_b32 v103, v4 offset:0
  ds_read_b128 v[104:107], v0 offset:0
  ds_read_b128 v[108:111], v0 offset:1024
L_s0:
  s_waitcnt lgkmcnt(0)
  v_readfirstlane_b32 s54, v103
  s_nop 0
  s_cmp_lt_u32 s54, s50
  s_cbranch_scc1 L_r0
  s_add_u32 s50, s50, 4
  ds_read_b32 v103, v4 offset:0
  ds_read_b128 v[112:115], v0 offset:2048
  ds_read_b128 v[116:119], v0 offset:3072
  v_cvt_f32_i32 v52, v104
  v_cvt_f32_i32 v54, v105
  v_cvt_f32_i32 v56, v106
  v_cvt_f32_i32 v58, v107
  v_cvt_f32_i32 v53, v108
  v_cvt_f32_i32 v55, v109
  v_cvt_f32_i32 v57, v110
  v_cvt_f32_i32 v59, v111
  v_pk_add_f32 v[52:53], v[52:53], v[36:37] neg_lo:[0,1] neg_hi:[0,1]
  v_pk_add_f32 v[54:55], v[54:55], v[36:37] neg_lo:[0,1] neg_hi:[0,1]
  v_pk_add_f32 v[56:57], v[56:57], v[36:37] neg_lo:[0,1] neg_hi:[0,1]
  v_pk_add_f32 v[58:59], v[58:59], v[36:37] neg_lo:[0,1] neg_hi:[0,1]
  v_cvt_pk_bf16_f32 v60, v52, v53
  v_cvt_pk_bf16_f32 v64, v54, v55
  v_cvt_pk_bf16_f32 v68, v56, v57
  v_cvt_pk_bf16_f32 v72, v58, v59
  v_dot2_f32_bf16 v52, v60, v44, 0
  v_dot2_f32_bf16 v53, v60, v45, 0
  v_dot2_f32_bf16 v54, v64, v44, 0
  v_dot2_f32_bf16 v55, v64, v45, 0
  v_dot2_f32_bf16 v56, v68, v44, 0
  v_dot2_f32_bf16 v57, v68, v45, 0
  v_dot2_f32_bf16 v58, v72, v44, 0
  v_dot2_f32_bf16 v59, v72, v45, 0
  v_cvt_pk_bf16_f32 v60, v52, v53
  v_cvt_pk_bf16_f32 v64, v54, v55
  v_cvt_pk_bf16_f32 v68, v56, v57
  v_cvt_pk_bf16_f32 v72, v58, v59
  s_branch L_s1
L_r1:
  ds_read_b32 v103, v4 offset:0
  ds_read_b128 v[112:115], v0 offset:2048
  ds_read_b128 v[116:119], v0 offset:3072
L_s1:
  s_waitcnt lgkmcnt(0)
  v_readfirstlane_b32 s54, v103
  s_nop 0
  s_cmp_lt_u32 s54, s50
  s_cbranch_scc1 L_r1
  s_add_u32 s50, s50, 4
  ds_read_b32 v103, v4 offset:0
  ds_read_b128 v[120:123], v0 offset:4096
  ds_read_b128 v[124:127], v0 offset:5120
  v_cvt_f32_i32 v52, v112
  v_cvt_f32_i32 v54, v113
  v_cvt_f32_i32 v56, v114
  v_cvt_f32_i32 v58, v115
  v_cvt_f32_i32 v53, v116
  v_cvt_f32_i32 v55, v117
  v_cvt_f32_i32 v57, v118
  v_cvt_f32_i32 v59, v119
  v_pk_add_f32 v[52:53], v[52:53], v[38:39] neg_lo:[0,1] neg_hi:[0,1]
  v_pk_add_f32 v[54:55], v[54:55], v[38:39] neg_lo:[0,1] neg_hi:[0,1]
  v_pk_add_f32 v[56:57], v[56:57], v[38:39] neg_lo:[0,1] neg_hi:[0,1]
  v_pk_add_f32 v[58:59], v[58:59], v[38:39] neg_lo:[0,1] neg_hi:[0,1]
  v_cvt_pk_bf16_f32 v61, v52, v53
  v_cvt_pk_bf16_f32 v65, v54, v55
  v_cvt_pk_bf16_f32 v69, v56, v57
  v_cvt_pk_bf16_f32 v73, v58, v59
  v_dot2_f32_bf16 v52, v61, v46, 0
  v_dot2_f32_bf16 v53, v61, v47, 0
  v_dot2_f32_bf16 v54, v65, v46, 0
  v_dot2_f32_bf16 v55, v65, v47, 0
  v_dot2_f32_bf16 v56, v69, v46, 0
  v_dot2_f32_bf16 v57, v69, v47, 0
  v_dot2_f32_bf16 v58, v73, v46, 0
  v_dot2_f32_bf16 v59, v73, v47, 0
  v_cvt_pk_bf16_f32 v61, v52, v53
  v_cvt_pk_bf16_f32 v65, v54, v55
  v_cvt_pk_bf16_f32 v69, v56, v57
  v_cvt_pk_bf16_f32 v73, v58, v59
  s_branch L_s2
L_r2:
  ds_read_b32 v103, v4 offset:0
  ds_read_b128 v[120:123], v0 offset:4096
  ds_read_b128 v[124:127], v0 offset:5120
L_s2:
  s_waitcnt lgkmcnt(0)
  v_readfirstlane_b32 s54, v103
  s_nop 0
  s_cmp_lt_u32 s54, s50
  s_cbranch_scc1 L_r2
  s_add_u32 s50, s50, 4
  ds_read_b32 v103, v4 offset:0
  ds_read_b128 v[128:131], v0 offset:6144
  ds_read_b128 v[132:135], v0 offset:7168
  v_cvt_f32_i32 v52, v120
  v_cvt_f32_i32 v54, v121
  v_cvt_f32_i32 v56, v122
  v_cvt_f32_i32 v58, v123
  v_cvt_f32_i32 v53, v124
  v_cvt_f32_i32 v55, v125
  v_cvt_f32_i32 v57, v126
  v_cvt_f32_i32 v59, v127
  v_pk_add_f32 v[52:53], v[52:53], v[40:41] neg_lo:[0,1] neg_hi:[0,1]
  v_pk_add_f32 v[54:55], v[54:55], v[40:41] neg_lo:[0,1] neg_hi:[0,1]
  v_pk_add_f32 v[56:57], v[56:57], v[40:41] neg_lo:[0,1] neg_hi:[0,1]
  v_pk_add_f32 v[58:59], v[58:59], v[40:41] neg_lo:[0,1] neg_hi:[0,1]
  v_cvt_pk_bf16_f32 v62, v52, v53
  v_cvt_pk_bf16_f32 v66, v54, v55
  v_cvt_pk_bf16_f32 v70, v56, v57
  v_cvt_pk_bf16_f32 v74, v58, v59
  v_dot2_f32_bf16 v52, v62, v48, 0
  v_dot2_f32_bf16 v53, v62, v49, 0
  v_dot2_f32_bf16 v54, v66, v48, 0
  v_dot2_f32_bf16 v55, v66, v49, 0
  v_dot2_f32_bf16 v56, v70, v48, 0
  v_dot2_f32_bf16 v57, v70, v49, 0
  v_dot2_f32_bf16 v58, v74, v48, 0
  v_dot2_f32_bf16 v59, v74, v49, 0
  v_cvt_pk_bf16_f32 v62, v52, v53
  v_cvt_pk_bf16_f32 v66, v54, v55
  v_cvt_pk_bf16_f32 v70, v56, v57
  v_cvt_pk_bf16_f32 v74, v58, v59
  s_branch L_s3
L_r3:
  ds_read_b32 v103, v4 offset:0
  ds_read_b128 v[128:131], v0 offset:6144
  ds_read_b128 v[132:135], v0 offset:7168
L_s3:
  s_waitcnt lgkmcnt(0)
  v_readfirstlane_b32 s54, v103
  s_nop 0
  s_cmp_lt_u32 s54, s50
  s_cbranch_scc1 L_r3
  s_add_u32 s50, s50, 4
  v_cvt_f32_i32 v52, v128
  v_cvt_f32_i32 v54, v129
  v_cvt_f32_i32 v56, v130
  v_cvt_f32_i32 v58, v131
  v_cvt_f32_i32 v53, v132
  v_cvt_f32_i32 v55, v133
  v_cvt_f32_i32 v57, v134
  v_cvt_f32_i32 v59, v135
  v_pk_add_f32 v[52:53], v[52:53], v[42:43] neg_lo:[0,1] neg_hi:[0,1]
  v_pk_add_f32 v[54:55], v[54:55], v[42:43] neg_lo:[0,1] neg_hi:[0,1]
  v_pk_add_f32 v[56:57], v[56:57], v[42:43] neg_lo:[0,1] neg_hi:[0,1]
  v_pk_add_f32 v[58:59], v[58:59], v[42:43] neg_lo:[0,1] neg_hi:[0,1]
  v_cvt_pk_bf16_f32 v63, v52, v53
  v_cvt_pk_bf16_f32 v67, v54, v55
  v_cvt_pk_bf16_f32 v71, v56, v57
  v_cvt_pk_bf16_f32 v75, v58, v59
  v_dot2_f32_bf16 v52, v63, v50, 0
  v_dot2_f32_bf16 v53, v63, v51, 0
  v_dot2_f32_bf16 v54, v67, v50, 0
  v_dot2_f32_bf16 v55, v67, v51, 0
  v_dot2_f32_bf16 v56, v71, v50, 0
  v_dot2_f32_bf16 v57, v71, v51, 0
  v_dot2_f32_bf16 v58, v75, v50, 0
  v_dot2_f32_bf16 v59, v75, v51, 0
  v_cvt_pk_bf16_f32 v63, v52, v53
  v_cvt_pk_bf16_f32 v67, v54, v55
  v_cvt_pk_bf16_f32 v71, v56, v57
  v_cvt_pk_bf16_f32 v75, v58, v59
  v_mfma_f32_16x16x32_bf16 v[76:79], v[92:95], v[60:63], v[76:79]
  v_mfma_f32_16x16x32_bf16 v[80:83], v[92:95], v[64:67], v[80:83]
  v_mfma_f32_16x16x32_bf16 v[84:87], v[92:95], v[68:71], v[84:87]
  v_mfma_f32_16x16x32_bf16 v[88:91], v[92:95], v[72:75], v[88:91]
  s_cmp_eq_u32 s3, 3
  s_cbranch_scc1 L_w3
  s_nop 2
  v_add_f32 v12, v76, v77
  v_add_f32 v52, v78, v79
  v_add_f32 v13, v80, v81
  v_add_f32 v53, v82, v83
  v_add_f32 v14, v84, v85
  v_add_f32 v54, v86, v87
  v_add_f32 v15, v88, v89
  v_add_f32 v55, v90, v91
  v_permlane32_swap_b32 v12, v52
  v_permlane32_swap_b32 v13, v53
  v_permlane32_swap_b32 v14, v54
  v_permlane32_swap_b32 v15, v55
  ds_write_b128 v97, v[12:15]
  ds_write_b32 v5, v101 offset:16
  s_waitcnt lgkmcnt(0)
  s_cbranch_execnz L_end
L_o0:
  ds_read_b128 v[156:159], v4 offset:16
  ds_read_b32 v9, v4 offset:48
  ds_read_b128 v[148:151], v100 offset:352
  ds_read_b128 v[136:139], v99 offset:0
  ds_read_b128 v[140:143], v99 offset:1024
  ds_read_b128 v[144:147], v99 offset:2048
  s_cbranch_execnz L_o1
L_w3:
  ds_read_b128 v[156:159], v4 offset:16
  ds_read_b32 v9, v4 offset:48
  ds_read_b128 v[148:151], v100 offset:352
  ds_read_b128 v[136:139], v99 offset:0
  ds_read_b128 v[140:143], v99 offset:1024
  ds_read_b128 v[144:147], v99 offset:2048
  v_add_f32 v12, v76, v77
  v_add_f32 v52, v78, v79
  v_add_f32 v13, v80, v81
  v_add_f32 v53, v82, v83
  v_add_f32 v14, v84, v85
  v_add_f32 v54, v86, v87
  v_add_f32 v8, v88, v89
  v_add_f32 v55, v90, v91
  v_permlane32_swap_b32 v12, v52
  v_permlane32_swap_b32 v13, v53
  v_permlane32_swap_b32 v14, v54
  v_permlane32_swap_b32 v8, v55
L_o1:
  s_waitcnt lgkmcnt(0)
  v_min3_u32 v156, v156, v157, v158
  v_readfirstlane_b32 s57, v9
  v_readfirstlane_b32 s54, v156
  s_cmp_eq_u32 s57, 0
  s_cbranch_scc1 L_o0
  s_cmp_lt_u32 s54, 129
  s_cbranch_scc1 L_o0
  s_and_b32 s54, s57, 31
  s_cmp_eq_u32 s54, s53
  v_add_f32 v136, v136, v140
  v_add_f32 v137, v137, v141
  v_add_f32 v138, v138, v142
  v_add_f32 v139, v139, v143
  v_add_f32 v136, v136, v144
  v_add_f32 v137, v137, v145
  v_add_f32 v138, v138, v146
  v_add_f32 v139, v139, v147
  v_add_f32 v11, v148, v149
  v_add_f32 v150, v150, v151
  v_mov_b32 v15, v9
  v_add_f32 v11, v11, v150
  v_add_f32 v12, v136, v12
  v_add_f32 v13, v137, v13
  v_add_f32 v14, v138, v14
  v_add_f32 v8, v139, v8
  v_perm_b32 v12, v12, v8, s61
  v_perm_b32 v13, v13, v8, s62
  v_perm_b32 v14, v14, v8, s63
  s_cbranch_scc1 L_sf
  buffer_store_dwordx4 v[12:15], v98, s[24:27], s56 offen sc1
  s_mov_b64 exec, s[44:45]
  buffer_store_dwordx4 v[8:11], v102, s[24:27], s46 offen sc1
  s_mov_b64 exec, s[42:43]
  s_branch L_sd
L_sf:
  buffer_store_dwordx4 v[12:15], v98, s[24:27], s56 offen
  s_mov_b64 exec, s[44:45]
  buffer_store_dwordx4 v[8:11], v102, s[24:27], s46 offen
  s_mov_b64 exec, s[42:43]
L_sd:
  s_xor_b32 s56, s2, s48
  s_and_b32 s56, s56, 7
  s_cbranch_scc1 L_end
  s_lshl_b32 s56, s48, 13
  s_andn2_b32 s46, s46, 255
  s_add_u32 s54, s56, 4096
  buffer_load_dwordx4 v[64:67], v20, s[24:27], s46 offen sc1
  buffer_load_dwordx4 v[32:35], v98, s[24:27], s56 offen offset:0 sc1
  buffer_load_dwordx4 v[36:39], v98, s[24:27], s56 offen offset:1024 sc1
  buffer_load_dwordx4 v[40:43], v98, s[24:27], s56 offen offset:2048 sc1
  buffer_load_dwordx4 v[44:47], v98, s[24:27], s56 offen offset:3072 sc1
  buffer_load_dwordx4 v[48:51], v98, s[24:27], s54 offen offset:0 sc1
  buffer_load_dwordx4 v[52:55], v98, s[24:27], s54 offen offset:1024 sc1
  buffer_load_dwordx4 v[56:59], v98, s[24:27], s54 offen offset:2048 sc1
  buffer_load_dwordx4 v[60:63], v98, s[24:27], s54 offen offset:3072 sc1
  s_sleep 4
L_poll:
  buffer_load_dwordx4 v[136:139], v20, s[24:27], s46 offen sc1
  buffer_load_dwordx4 v[104:107], v98, s[24:27], s56 offen offset:0 sc1
  buffer_load_dwordx4 v[108:111], v98, s[24:27], s56 offen offset:1024 sc1
  buffer_load_dwordx4 v[112:115], v98, s[24:27], s56 offen offset:2048 sc1
  buffer_load_dwordx4 v[116:119], v98, s[24:27], s56 offen offset:3072 sc1
  buffer_load_dwordx4 v[120:123], v98, s[24:27], s54 offen offset:0 sc1
  buffer_load_dwordx4 v[124:127], v98, s[24:27], s54 offen offset:1024 sc1
  buffer_load_dwordx4 v[128:131], v98, s[24:27], s54 offen offset:2048 sc1
  buffer_load_dwordx4 v[132:135], v98, s[24:27], s54 offen offset:3072 sc1
  s_waitcnt vmcnt(16)
  v_xor_b32 v16, v9, v65
  v_xor_b32 v17, v9, v35
  s_waitcnt vmcnt(15)
  v_xor_b32 v19, v9, v39
  s_waitcnt vmcnt(14)
  v_xor_b32 v18, v9, v43
  v_or3_b32 v16, v16, v18, v19
  s_waitcnt vmcnt(13)
  v_xor_b32 v19, v9, v47
  s_waitcnt vmcnt(12)
  v_xor_b32 v18, v9, v51
  v_or3_b32 v16, v16, v18, v19
  s_waitcnt vmcnt(11)
  v_xor_b32 v19, v9, v55
  s_waitcnt vmcnt(10)
  v_xor_b32 v18, v9, v59
  v_or3_b32 v16, v16, v18, v19
  s_waitcnt vmcnt(9)
  v_xor_b32 v19, v9, v63
  v_or3_b32 v16, v16, v17, v19
  v_mov_b32 v17, 0
  v_cmp_ne_u32 vcc, v16, v17
  s_sub_u32 s60, s60, 1
  s_cselect_b64 vcc, 0, vcc
  s_or_b64 vcc, vcc, s[36:37]
  s_cbranch_vccz L_finA
  buffer_load_dwordx4 v[64:67], v20, s[24:27], s46 offen sc1
  buffer_load_dwordx4 v[32:35], v98, s[24:27], s56 offen offset:0 sc1
  buffer_load_dwordx4 v[36:39], v98, s[24:27], s56 offen offset:1024 sc1
  buffer_load_dwordx4 v[40:43], v98, s[24:27], s56 offen offset:2048 sc1
  buffer_load_dwordx4 v[44:47], v98, s[24:27], s56 offen offset:3072 sc1
  buffer_load_dwordx4 v[48:51], v98, s[24:27], s54 offen offset:0 sc1
  buffer_load_dwordx4 v[52:55], v98, s[24:27], s54 offen offset:1024 sc1
  buffer_load_dwordx4 v[56:59], v98, s[24:27], s54 offen offset:2048 sc1
  buffer_load_dwordx4 v[60:63], v98, s[24:27], s54 offen offset:3072 sc1
  s_waitcnt vmcnt(16)
  v_xor_b32 v16, v9, v137
  v_xor_b32 v17, v9, v107
  s_waitcnt vmcnt(15)
  v_xor_b32 v19, v9, v111
  s_waitcnt vmcnt(14)
  v_xor_b32 v18, v9, v115
  v_or3_b32 v16, v16, v18, v19
  s_waitcnt vmcnt(13)
  v_xor_b32 v19, v9, v119
  s_waitcnt vmcnt(12)
  v_xor_b32 v18, v9, v123
  v_or3_b32 v16, v16, v18, v19
  s_waitcnt vmcnt(11)
  v_xor_b32 v19, v9, v127
  s_waitcnt vmcnt(10)
  v_xor_b32 v18, v9, v131
  v_or3_b32 v16, v16, v18, v19
  s_waitcnt vmcnt(9)
  v_xor_b32 v19, v9, v135
  v_or3_b32 v16, v16, v17, v19
  v_mov_b32 v17, 0
  v_cmp_ne_u32 vcc, v16, v17
  s_sub_u32 s60, s60, 1
  s_cselect_b64 vcc, 0, vcc
  s_cbranch_vccnz L_poll
  v_max_f32_dpp v10, v138, v138 quad_perm:[1,0,3,2] row_mask:0xf bank_mask:0xf
  v_perm_b32 v107, v106, v105, s38
  v_perm_b32 v111, v110, v109, s38
  v_max_f32_dpp v10, v10, v10 quad_perm:[2,3,0,1] row_mask:0xf bank_mask:0xf
  v_perm_b32 v115, v114, v113, s38
  v_perm_b32 v119, v118, v117, s38
  v_max_f32_dpp v10, v10, v10 row_half_mirror row_mask:0xf bank_mask:0xf
  v_perm_b32 v123, v122, v121, s38
  v_perm_b32 v127, v126, v125, s38
  v_sub_f32 v10, v138, v10
  v_mul_f32 v10, s47, v10
  v_exp_f32 v10, v10
  v_perm_b32 v131, v130, v129, s38
  v_perm_b32 v135, v134, v133, s38
  v_mul_f32 v11, v10, v139
  v_perm_b32 v107, v107, v104, s39
  v_perm_b32 v111, v111, v108, s39
  v_add_f32_dpp v11, v11, v11 quad_perm:[1,0,3,2] row_mask:0xf bank_mask:0xf
  v_perm_b32 v115, v115, v112, s39
  v_perm_b32 v119, v119, v116, s39
  v_add_f32_dpp v11, v11, v11 quad_perm:[2,3,0,1] row_mask:0xf bank_mask:0xf
  v_perm_b32 v123, v123, v120, s39
  v_perm_b32 v127, v127, v124, s39
  v_add_f32_dpp v11, v11, v11 row_half_mirror row_mask:0xf bank_mask:0xf
  v_perm_b32 v131, v131, v128, s39
  v_perm_b32 v135, v135, v132, s39
  v_rcp_f32 v11, v11
  v_lshrrev_b32 v9, 1, v98
  v_mul_f32 v10, v10, v11
  s_nop 1
  v_mul_f32_dpp v12, v10, v104 row_newbcast:0 row_mask:0xf bank_mask:0xf
  v_mul_f32_dpp v13, v10, v105 row_newbcast:0 row_mask:0xf bank_mask:0xf
  v_mul_f32_dpp v14, v10, v106 row_newbcast:0 row_mask:0xf bank_mask:0xf
  v_mul_f32_dpp v15, v10, v107 row_newbcast:0 row_mask:0xf bank_mask:0xf
  v_fmac_f32_dpp v12, v10, v108 row_newbcast:1 row_mask:0xf bank_mask:0xf
  v_fmac_f32_dpp v13, v10, v109 row_newbcast:1 row_mask:0xf bank_mask:0xf
  v_fmac_f32_dpp v14, v10, v110 row_newbcast:1 row_mask:0xf bank_mask:0xf
  v_fmac_f32_dpp v15, v10, v111 row_newbcast:1 row_mask:0xf bank_mask:0xf
  v_fmac_f32_dpp v12, v10, v112 row_newbcast:2 row_mask:0xf bank_mask:0xf
  v_fmac_f32_dpp v13, v10, v113 row_newbcast:2 row_mask:0xf bank_mask:0xf
  v_fmac_f32_dpp v14, v10, v114 row_newbcast:2 row_mask:0xf bank_mask:0xf
  v_fmac_f32_dpp v15, v10, v115 row_newbcast:2 row_mask:0xf bank_mask:0xf
  v_fmac_f32_dpp v12, v10, v116 row_newbcast:3 row_mask:0xf bank_mask:0xf
  v_fmac_f32_dpp v13, v10, v117 row_newbcast:3 row_mask:0xf bank_mask:0xf
  v_fmac_f32_dpp v14, v10, v118 row_newbcast:3 row_mask:0xf bank_mask:0xf
  v_fmac_f32_dpp v15, v10, v119 row_newbcast:3 row_mask:0xf bank_mask:0xf
  v_fmac_f32_dpp v12, v10, v120 row_newbcast:4 row_mask:0xf bank_mask:0xf
  v_fmac_f32_dpp v13, v10, v121 row_newbcast:4 row_mask:0xf bank_mask:0xf
  v_fmac_f32_dpp v14, v10, v122 row_newbcast:4 row_mask:0xf bank_mask:0xf
  v_fmac_f32_dpp v15, v10, v123 row_newbcast:4 row_mask:0xf bank_mask:0xf
  v_fmac_f32_dpp v12, v10, v124 row_newbcast:5 row_mask:0xf bank_mask:0xf
  v_fmac_f32_dpp v13, v10, v125 row_newbcast:5 row_mask:0xf bank_mask:0xf
  v_fmac_f32_dpp v14, v10, v126 row_newbcast:5 row_mask:0xf bank_mask:0xf
  v_fmac_f32_dpp v15, v10, v127 row_newbcast:5 row_mask:0xf bank_mask:0xf
  v_fmac_f32_dpp v12, v10, v128 row_newbcast:6 row_mask:0xf bank_mask:0xf
  v_fmac_f32_dpp v13, v10, v129 row_newbcast:6 row_mask:0xf bank_mask:0xf
  v_fmac_f32_dpp v14, v10, v130 row_newbcast:6 row_mask:0xf bank_mask:0xf
  v_fmac_f32_dpp v15, v10, v131 row_newbcast:6 row_mask:0xf bank_mask:0xf
  v_fmac_f32_dpp v12, v10, v132 row_newbcast:7 row_mask:0xf bank_mask:0xf
  v_fmac_f32_dpp v13, v10, v133 row_newbcast:7 row_mask:0xf bank_mask:0xf
  v_fmac_f32_dpp v14, v10, v134 row_newbcast:7 row_mask:0xf bank_mask:0xf
  v_fmac_f32_dpp v15, v10, v135 row_newbcast:7 row_mask:0xf bank_mask:0xf
  v_cvt_pk_bf16_f32 v12, v12, v13
  v_cvt_pk_bf16_f32 v13, v14, v15
  buffer_store_dwordx2 v[12:13], v9, s[28:31], s55 offen
  s_cbranch_execz L_finA
  s_waitcnt vmcnt(0)
  s_endpgm
L_finA:
  v_max_f32_dpp v10, v66, v66 quad_perm:[1,0,3,2] row_mask:0xf bank_mask:0xf
  v_perm_b32 v35, v34, v33, s38
  v_perm_b32 v39, v38, v37, s38
  v_max_f32_dpp v10, v10, v10 quad_perm:[2,3,0,1] row_mask:0xf bank_mask:0xf
  v_perm_b32 v43, v42, v41, s38
  v_perm_b32 v47, v46, v45, s38
  v_max_f32_dpp v10, v10, v10 row_half_mirror row_mask:0xf bank_mask:0xf
  v_perm_b32 v51, v50, v49, s38
  v_perm_b32 v55, v54, v53, s38
  v_sub_f32 v10, v66, v10
  v_mul_f32 v10, s47, v10
  v_exp_f32 v10, v10
  v_perm_b32 v59, v58, v57, s38
  v_perm_b32 v63, v62, v61, s38
  v_mul_f32 v11, v10, v67
  v_perm_b32 v35, v35, v32, s39
  v_perm_b32 v39, v39, v36, s39
  v_add_f32_dpp v11, v11, v11 quad_perm:[1,0,3,2] row_mask:0xf bank_mask:0xf
  v_perm_b32 v43, v43, v40, s39
  v_perm_b32 v47, v47, v44, s39
  v_add_f32_dpp v11, v11, v11 quad_perm:[2,3,0,1] row_mask:0xf bank_mask:0xf
  v_perm_b32 v51, v51, v48, s39
  v_perm_b32 v55, v55, v52, s39
  v_add_f32_dpp v11, v11, v11 row_half_mirror row_mask:0xf bank_mask:0xf
  v_perm_b32 v59, v59, v56, s39
  v_perm_b32 v63, v63, v60, s39
  v_rcp_f32 v11, v11
  v_lshrrev_b32 v9, 1, v98
  v_mul_f32 v10, v10, v11
  s_nop 1
  v_mul_f32_dpp v12, v10, v32 row_newbcast:0 row_mask:0xf bank_mask:0xf
  v_mul_f32_dpp v13, v10, v33 row_newbcast:0 row_mask:0xf bank_mask:0xf
  v_mul_f32_dpp v14, v10, v34 row_newbcast:0 row_mask:0xf bank_mask:0xf
  v_mul_f32_dpp v15, v10, v35 row_newbcast:0 row_mask:0xf bank_mask:0xf
  v_fmac_f32_dpp v12, v10, v36 row_newbcast:1 row_mask:0xf bank_mask:0xf
  v_fmac_f32_dpp v13, v10, v37 row_newbcast:1 row_mask:0xf bank_mask:0xf
  v_fmac_f32_dpp v14, v10, v38 row_newbcast:1 row_mask:0xf bank_mask:0xf
  v_fmac_f32_dpp v15, v10, v39 row_newbcast:1 row_mask:0xf bank_mask:0xf
  v_fmac_f32_dpp v12, v10, v40 row_newbcast:2 row_mask:0xf bank_mask:0xf
  v_fmac_f32_dpp v13, v10, v41 row_newbcast:2 row_mask:0xf bank_mask:0xf
  v_fmac_f32_dpp v14, v10, v42 row_newbcast:2 row_mask:0xf bank_mask:0xf
  v_fmac_f32_dpp v15, v10, v43 row_newbcast:2 row_mask:0xf bank_mask:0xf
  v_fmac_f32_dpp v12, v10, v44 row_newbcast:3 row_mask:0xf bank_mask:0xf
  v_fmac_f32_dpp v13, v10, v45 row_newbcast:3 row_mask:0xf bank_mask:0xf
  v_fmac_f32_dpp v14, v10, v46 row_newbcast:3 row_mask:0xf bank_mask:0xf
  v_fmac_f32_dpp v15, v10, v47 row_newbcast:3 row_mask:0xf bank_mask:0xf
  v_fmac_f32_dpp v12, v10, v48 row_newbcast:4 row_mask:0xf bank_mask:0xf
  v_fmac_f32_dpp v13, v10, v49 row_newbcast:4 row_mask:0xf bank_mask:0xf
  v_fmac_f32_dpp v14, v10, v50 row_newbcast:4 row_mask:0xf bank_mask:0xf
  v_fmac_f32_dpp v15, v10, v51 row_newbcast:4 row_mask:0xf bank_mask:0xf
  v_fmac_f32_dpp v12, v10, v52 row_newbcast:5 row_mask:0xf bank_mask:0xf
  v_fmac_f32_dpp v13, v10, v53 row_newbcast:5 row_mask:0xf bank_mask:0xf
  v_fmac_f32_dpp v14, v10, v54 row_newbcast:5 row_mask:0xf bank_mask:0xf
  v_fmac_f32_dpp v15, v10, v55 row_newbcast:5 row_mask:0xf bank_mask:0xf
  v_fmac_f32_dpp v12, v10, v56 row_newbcast:6 row_mask:0xf bank_mask:0xf
  v_fmac_f32_dpp v13, v10, v57 row_newbcast:6 row_mask:0xf bank_mask:0xf
  v_fmac_f32_dpp v14, v10, v58 row_newbcast:6 row_mask:0xf bank_mask:0xf
  v_fmac_f32_dpp v15, v10, v59 row_newbcast:6 row_mask:0xf bank_mask:0xf
  v_fmac_f32_dpp v12, v10, v60 row_newbcast:7 row_mask:0xf bank_mask:0xf
  v_fmac_f32_dpp v13, v10, v61 row_newbcast:7 row_mask:0xf bank_mask:0xf
  v_fmac_f32_dpp v14, v10, v62 row_newbcast:7 row_mask:0xf bank_mask:0xf
  v_fmac_f32_dpp v15, v10, v63 row_newbcast:7 row_mask:0xf bank_mask:0xf
  v_cvt_pk_bf16_f32 v12, v12, v13
  v_cvt_pk_bf16_f32 v13, v14, v15
  buffer_store_dwordx2 v[12:13], v9, s[28:31], s55 offen
  s_cbranch_execz L_end
  s_waitcnt vmcnt(0)
  s_endpgm
L_helper:
  s_lshr_b32 s51, s49, 3
  s_lshl_b32 s54, s49, 7
  s_or_b32 s53, s53, 16
  s_add_u32 s54, s54, 655360
  v_mov_b32 v3, s54
  s_mov_b32 s72, 8
  s_mov_b32 s74, 0
  s_mov_b32 s76, 1684
  s_mov_b32 s75, 0
  s_mov_b64 s[70:71], 0
  s_waitcnt lgkmcnt(0)
  v_mov_b32 v13, 0
  s_mul_i32 s55, s48, 8
  v_mov_b32 v16, s55
  s_add_u32 s62, s20, s55
  s_addc_u32 s63, s21, 0
  s_mul_i32 s78, s48, 3
  s_lshr_b32 s78, s78, 3
  s_xor_b32 s54, s2, s48
  s_and_b32 s54, s54, 7
  s_cselect_b32 s78, 14, s78
  s_cselect_b32 s41, 15, s53
  s_add_u32 s82, s22, 655360
  s_addc_u32 s83, s23, 0
L_hr:
  s_add_u32 s56, s72, 0
L_hwa:
  s_sleep 4
  ds_read_b64 v[8:9], v4 offset:40
  s_waitcnt lgkmcnt(0)
  v_readfirstlane_b32 s54, v8
  s_nop 0
  s_cmp_lt_u32 s54, s56
  s_cbranch_scc1 L_hwa
  v_readfirstlane_b32 s55, v9
  s_memrealtime s[80:81]
  s_sub_u32 s54, s54, s72
  s_mul_i32 s54, s54, 27
  s_sub_u32 s73, s55, s54
  s_cmp_lg_u32 s51, s74
  s_cbranch_scc1 L_hs
  s_waitcnt lgkmcnt(0)
  v_mov_b32 v6, s73
  v_mov_b32 v7, s81
  s_mov_b64 exec, 1
  global_store_dwordx2 v3, v[6:7], s[22:23] sc1
  s_mov_b64 exec, -1
L_hs:
  s_add_u32 s56, s72, 16
L_hwe:
  s_sleep 4
  ds_read_b64 v[8:9], v4 offset:40
  s_waitcnt lgkmcnt(0)
  v_readfirstlane_b32 s54, v8
  s_nop 0
  s_cmp_lt_u32 s54, s56
  s_cbranch_scc1 L_hwe
  s_load_dwordx2 s[84:85], s[82:83], 0
  s_load_dwordx2 s[86:87], s[82:83], 128
  s_load_dwordx2 s[88:89], s[82:83], 256
  s_load_dwordx2 s[90:91], s[82:83], 384
  s_load_dwordx2 s[92:93], s[82:83], 512
  s_load_dwordx2 s[94:95], s[82:83], 640
  s_load_dwordx2 s[96:97], s[82:83], 768
  s_load_dwordx2 s[98:99], s[82:83], 896
  s_mov_b32 s55, 0
  s_mov_b32 s56, 0
  s_waitcnt lgkmcnt(0)
  s_sub_u32 s54, s73, s84
  s_xor_b32 s57, s85, s81
  s_cselect_b32 s54, 0x10000, s54
  s_add_u32 s57, s54, 2048
  s_cmp_lt_u32 s57, 4096
  s_cselect_b32 s54, s54, -420
  s_addc_u32 s56, s56, 0
  s_add_u32 s55, s55, s54
  s_sub_u32 s54, s73, s86
  s_xor_b32 s57, s87, s81
  s_cselect_b32 s54, 0x10000, s54
  s_add_u32 s57, s54, 2048
  s_cmp_lt_u32 s57, 4096
  s_cselect_b32 s54, s54, -420
  s_addc_u32 s56, s56, 0
  s_add_u32 s55, s55, s54
  s_sub_u32 s54, s73, s88
  s_xor_b32 s57, s89, s81
  s_cselect_b32 s54, 0x10000, s54
  s_add_u32 s57, s54, 2048
  s_cmp_lt_u32 s57, 4096
  s_cselect_b32 s54, s54, -420
  s_addc_u32 s56, s56, 0
  s_add_u32 s55, s55, s54
  s_sub_u32 s54, s73, s90
  s_xor_b32 s57, s91, s81
  s_cselect_b32 s54, 0x10000, s54
  s_add_u32 s57, s54, 2048
  s_cmp_lt_u32 s57, 4096
  s_cselect_b32 s54, s54, -420
  s_addc_u32 s56, s56, 0
  s_add_u32 s55, s55, s54
  s_sub_u32 s54, s73, s92
  s_xor_b32 s57, s93, s81
  s_cselect_b32 s54, 0x10000, s54
  s_add_u32 s57, s54, 2048
  s_cmp_lt_u32 s57, 4096
  s_cselect_b32 s54, s54, -420
  s_addc_u32 s56, s56, 0
  s_add_u32 s55, s55, s54
  s_sub_u32 s54, s73, s94
  s_xor_b32 s57, s95, s81
  s_cselect_b32 s54, 0x10000, s54
  s_add_u32 s57, s54, 2048
  s_cmp_lt_u32 s57, 4096
  s_cselect_b32 s54, s54, -420
  s_addc_u32 s56, s56, 0
  s_add_u32 s55, s55, s54
  s_sub_u32 s54, s73, s96
  s_xor_b32 s57, s97, s81
  s_cselect_b32 s54, 0x10000, s54
  s_add_u32 s57, s54, 2048
  s_cmp_lt_u32 s57, 4096
  s_cselect_b32 s54, s54, -420
  s_addc_u32 s56, s56, 0
  s_add_u32 s55, s55, s54
  s_sub_u32 s54, s73, s98
  s_xor_b32 s57, s99, s81
  s_cselect_b32 s54, 0x10000, s54
  s_add_u32 s57, s54, 2048
  s_cmp_lt_u32 s57, 4096
  s_cselect_b32 s54, s54, -420
  s_addc_u32 s56, s56, 0
  s_add_u32 s55, s55, s54
  s_cmp_ge_u32 s56, 5
  s_cselect_b32 s55, s55, 0
  s_ashr_i32 s55, s55, 3
  s_sub_u32 s55, s73, s55
  s_lshr_b32 s56, s76, 1
  s_add_u32 s75, s75, s56
  s_sub_u32 s54, s55, s70
  s_mov_b32 s70, s55
  s_lshl_b32 s54, s54, 1
  s_cmp_eq_u32 s74, 0
  s_cselect_b32 s54, 0, s54
  s_min_i32 s56, s54, s71
  s_mov_b32 s71, s54
  s_sub_u32 s56, s56, 40
  s_max_i32 s76, s56, 1684
  s_sub_u32 s54, s55, s75
  s_abs_i32 s57, s54
  s_cmp_le_u32 s57, 30
  s_cselect_b32 s75, s75, s55
  s_cselect_b32 s54, s54, 0
  s_ashr_i32 s57, s54, 1
  s_add_u32 s75, s75, s57
  s_mov_b32 s55, s75
  s_mov_b32 s56, s76
  s_mul_i32 s54, s56, s72
  s_lshr_b32 s54, s54, 6
  s_sub_u32 s55, s55, s54
  v_mov_b32 v6, s55
  v_mov_b32 v7, s56
  ds_write_b64 v4, v[6:7] offset:32
  s_add_u32 s82, s82, 1024
  s_addc_u32 s83, s83, 0
  s_cmp_lg_u32 s74, s78
  s_cbranch_scc1 L_hnt
  s_add_u32 s56, s72, 24
L_hwt:
  s_sleep 4
  ds_read_b64 v[8:9], v4 offset:40
  s_waitcnt lgkmcnt(0)
  v_readfirstlane_b32 s54, v8
  s_nop 0
  s_cmp_lt_u32 s54, s56
  s_cbranch_scc1 L_hwt
  s_cmp_lg_u32 s78, 14
  s_cbranch_scc1 L_ht1
  s_load_dword s54, s[62:63], 0
  s_waitcnt lgkmcnt(0)
  v_mov_b32 v18, s54
  s_cmp_lg_u32 s54, 0
  s_cbranch_scc1 L_ht2
L_ht1:
  s_andn2_b32 s54, s80, 31
  s_or_b32 s54, s54, s41
  v_mov_b32 v12, s54
  s_mov_b64 exec, 1
  global_atomic_cmpswap v18, v16, v[12:13], s[20:21] sc0
  s_waitcnt vmcnt(0)
  v_cmp_eq_u32 vcc, 0, v18
  s_nop 1
  v_cndmask_b32 v18, v18, v12, vcc
L_ht2:
  s_mov_b64 exec, 1
  ds_write_b32 v4, v18 offset:48
  s_mov_b64 exec, -1
L_hnt:
  s_add_u32 s72, s72, 32
  s_add_u32 s74, s74, 1
  s_cmp_le_u32 s72, 456
  s_cbranch_scc1 L_hr
  s_waitcnt lgkmcnt(0)
  v_mov_b32 v0, v4
  v_mov_b32 v97, v4
  v_mov_b32 v99, v4
  v_mov_b32 v100, v4
  v_mov_b32 v5, v4
  v_lshlrev_b32 v98, 4, v96
  v_mov_b32 v103, -1
  v_mov_b32 v102, 0
  v_mov_b32 v20, 0
  v_mov_b32 v21, 0
  v_mov_b32 v9, 8
  v_mov_b32 v156, 0xff
  s_mov_b32 s50, 0
  s_mov_b64 s[36:37], -1
  s_mov_b64 exec, 0
  s_branch L_drain
L_end:
L_end2:
  s_endpgm
.section .rodata,"a"
.p2align 6
.amdhsa_kernel standalone__kv_cache_quant_int4_int2_kv_with_per_channel_or_per_token_scales__decode_kernel
  .amdhsa_next_free_vgpr 168
  .amdhsa_next_free_sgpr 100
  .amdhsa_accum_offset 168
  .amdhsa_group_segment_fixed_size 0
  .amdhsa_kernarg_size 80
  .amdhsa_user_sgpr_count 2
  .amdhsa_user_sgpr_kernarg_segment_ptr 1
  .amdhsa_system_sgpr_workgroup_id_x 1
  .amdhsa_float_denorm_mode_32 3
.end_amdhsa_kernel
```
